```python
import torch

def _softmax(x, axis=-1):
    return torch.softmax(x, dim=axis)
def _gelu(x):
    return torch.nn.functional.gelu(x, approximate="tanh")
def _silu(x):
    return torch.nn.functional.silu(x)
def _sigmoid(x):
    return torch.sigmoid(x)
def _layernorm(x, axis=-1, eps=1e-5):
    m = x.mean(dim=axis, keepdim=True)
    v = x.var(dim=axis, keepdim=True, unbiased=False)
    return (x - m) / torch.sqrt(v + eps)
def _scatter_add(tgt, idx, src, axis=0):
    return tgt.clone().index_add_(axis, idx, src)
def _segment_sum(src, seg, n):
    out = torch.zeros((n,) + src.shape[1:], dtype=src.dtype)
    return out.index_add_(0, seg, src)
def _pad(x, pw):
    flat = tuple(v for pair in reversed(pw) for v in pair)
    return torch.nn.functional.pad(x, flat)

kernel_name = 'interleave_layers__compressed_kv_cla__glu_gated_swiglu__decode'

def setup_inputs():

    _w = (lambda a: (lambda t: t.to(torch.bfloat16) if t.is_floating_point() else t)(torch.as_tensor(a)))
    def _A_setup():
        B, H, Sq, Sk, D, M = 2, 32, 1, 8192, 128, 512
        Dc = 4 * D
        return {
            "x": _w((lambda *s: torch.randn(*s, dtype=torch.bfloat16) * 0.05)(B, Sq, M)),
            "c_kv": _w((lambda *s: torch.randn(*s, dtype=torch.bfloat16) * 0.8)(B, Sk, Dc)),
            "w_q": _w((lambda *s: torch.randn(*s, dtype=torch.bfloat16) * 1.6)(M, H, D) * (M ** -0.5)),
            "w_uk": _w((lambda *s: torch.randn(*s, dtype=torch.bfloat16) * 1.6)(Dc, H, D) * (Dc ** -0.5)),
            "w_uv": _w((lambda *s: torch.randn(*s, dtype=torch.bfloat16) * 0.8)(Dc, H, D) * (Dc ** -0.5)),
            "w_o": _w((lambda *s: torch.randn(*s, dtype=torch.bfloat16) * 0.8)(H, D, M) * ((H * D) ** -0.5)),
        }
    _A_in = _A_setup()

    def _B_setup():
        B, S, D, F = 2, 1, 512, 1792
        return {
            "x": _w((lambda *s: torch.randn(*s, dtype=torch.bfloat16) * 0.05)(B, S, D)),
            "w1": _w((lambda *s: torch.randn(*s, dtype=torch.bfloat16) * 0.4)(D, F) * (2.0 / D) ** 0.5),
            "w3": _w((lambda *s: torch.randn(*s, dtype=torch.bfloat16) * 0.4)(D, F) * (2.0 / D) ** 0.5),
            "w2": _w((lambda *s: torch.randn(*s, dtype=torch.bfloat16) * 0.4)(F, D) * (2.0 / F) ** 0.5),
        }
    _B_in = _B_setup()

    return {
        "A_x": _A_in["x"],
        "A_c_kv": _A_in["c_kv"],
        "A_w_q": _A_in["w_q"],
        "A_w_uk": _A_in["w_uk"],
        "A_w_uv": _A_in["w_uv"],
        "A_w_o": _A_in["w_o"],
        "B_x": _B_in["x"],
        "B_w1": _B_in["w1"],
        "B_w3": _B_in["w3"],
        "B_w2": _B_in["w2"],
    }

def reference(A_x, A_c_kv, A_w_q, A_w_uk, A_w_uv, A_w_o, B_x, B_w1, B_w3, B_w2):
    def _A_ref(x, c_kv, w_q, w_uk, w_uv, w_o):
        B, Sq, M = x.shape[0], x.shape[1], x.shape[2]
        Sk = c_kv.shape[1]
        H, D = w_q.shape[1], w_q.shape[2]
        q = torch.einsum("bqm,mhd->bhqd", x, w_q)
        k = torch.einsum("bkc,chd->bhkd", c_kv, w_uk)
        v = torch.einsum("bkc,chd->bhkd", c_kv, w_uv)
        scores = torch.einsum("bhqd,bhkd->bhqk", q, k) * (D ** -0.5)
        off = Sk - Sq
        qi = torch.arange(Sq)[:, None]
        kj = torch.arange(Sk)[None, :]
        cmask = kj <= (qi + off)
        scores = torch.where(cmask[None, None], scores, -1e9)
        p = _softmax(scores, axis=-1)
        ctx = torch.einsum("bhqk,bhkd->bhqd", p, v)
        return torch.einsum("bhqd,hdm->bqm", ctx, w_o)

    def _B_ref(x, w1, w3, w2):
        gate = torch.einsum("bsd,df->bsf", x, w1)
        up = torch.einsum("bsd,df->bsf", x, w3)
        h = _silu(gate) * up
        out = torch.einsum("bsf,fd->bsd", h, w2)
        return out

    x = A_x
    x = x + _A_ref(_layernorm(x, axis=-1), A_c_kv, A_w_q, A_w_uk, A_w_uv, A_w_o)
    x = x + _B_ref(_layernorm(x, axis=-1), B_w1, B_w3, B_w2)
    x = x + _A_ref(_layernorm(x, axis=-1), A_c_kv, A_w_q, A_w_uk, A_w_uv, A_w_o)
    x = x + _B_ref(_layernorm(x, axis=-1), B_w1, B_w3, B_w2)
    return x
```

```asm
; @launch grid=(256,1,1) block=(512,1,1) lds=131072
.amdgcn_target "amdgcn-amd-amdhsa--gfx950"
.text
.globl interleave_layers__compressed_kv_cla__glu_gated_swiglu__decode_kernel
.p2align 8
.type interleave_layers__compressed_kv_cla__glu_gated_swiglu__decode_kernel,@function
interleave_layers__compressed_kv_cla__glu_gated_swiglu__decode_kernel:
    s_cmp_ge_u32 s2, 256
    s_cbranch_scc1 L_END
    s_load_dwordx16 s[64:79], s[0:1], 0
    s_load_dwordx8 s[80:87], s[0:1], 64
    s_load_dwordx2 s[88:89], s[0:1], 96
    v_lshrrev_b32 v1, 6, v0
    s_nop 0
    v_readfirstlane_b32 s4, v1
    v_and_b32 v1, 63, v0
    v_and_b32 v0, 255, v0
    s_lshr_b32 s98, s4, 2
    s_and_b32 s4, s4, 3
    v_lshlrev_b32 v2, 2, v1
    v_lshlrev_b32 v3, 4, v1
    s_and_b32 s58, s2, 7
    s_lshl_b32 s58, s58, 5
    s_lshr_b32 s59, s2, 3
    s_or_b32 s3, s58, s59
    s_lshr_b32 s56, s3, 5
    s_and_b32 s57, s3, 31
    s_mov_b32 s5, 0
    s_mov_b32 s6, 200000
    s_mov_b32 s7, 0
    s_mov_b32 s97, 0
    s_waitcnt lgkmcnt(0)
    s_mov_b32 s8, s64
    s_and_b32 s9, s65, 0xffff
    s_mov_b32 s10, 2048
    s_mov_b32 s11, 0x20000
    s_mov_b32 s12, s66
    s_and_b32 s13, s67, 0xffff
    s_mov_b32 s14, 16777216
    s_mov_b32 s15, 0x20000
    s_mov_b32 s16, s68
    s_and_b32 s17, s69, 0xffff
    s_mov_b32 s18, 4194304
    s_mov_b32 s19, 0x20000
    s_mov_b32 s20, s70
    s_and_b32 s21, s71, 0xffff
    s_mov_b32 s22, 4194304
    s_mov_b32 s23, 0x20000
    s_mov_b32 s24, s72
    s_and_b32 s25, s73, 0xffff
    s_mov_b32 s26, 4194304
    s_mov_b32 s27, 0x20000
    s_mov_b32 s28, s74
    s_and_b32 s29, s75, 0xffff
    s_mov_b32 s30, 4194304
    s_mov_b32 s31, 0x20000
    s_mov_b32 s32, s78
    s_and_b32 s33, s79, 0xffff
    s_mov_b32 s34, 1835008
    s_mov_b32 s35, 0x20000
    s_mov_b32 s36, s80
    s_and_b32 s37, s81, 0xffff
    s_mov_b32 s38, 1835008
    s_mov_b32 s39, 0x20000
    s_mov_b32 s40, s82
    s_and_b32 s41, s83, 0xffff
    s_mov_b32 s42, 1835008
    s_mov_b32 s43, 0x20000
    s_mov_b32 s44, s84
    s_and_b32 s45, s85, 0xffff
    s_mov_b32 s46, 2048
    s_mov_b32 s47, 0x20000
    s_mov_b32 s48, s86
    s_and_b32 s49, s87, 0xffff
    s_mov_b32 s50, 256
    s_mov_b32 s51, 0x20000
    s_mov_b32 s52, s88
    s_and_b32 s53, s89, 0xffff
    s_mov_b32 s54, 268435456
    s_mov_b32 s55, 0x20000
    v_mov_b32 v16, -1
    v_mov_b32 v17, -1
    v_mov_b32 v18, -1
    v_mov_b32 v19, -1
    s_lshl_b32 s58, s4, 9
    v_lshlrev_b32 v8, 3, v1
    buffer_load_dwordx2 v[6:7], v8, s[8:11], s58 offen
    s_cmp_eq_u32 s98, 1
    s_cbranch_scc1 L_GROUPB
    s_and_b32 s58, s3, 3
    s_lshl_b32 s58, s58, 2
    s_add_u32 s58, s58, s4
    s_lshl_b32 s58, s58, 18
    s_lshr_b32 s59, s3, 2
    s_lshl_b32 s59, s59, 7
    s_add_u32 s58, s58, s59
    v_lshrrev_b32 v8, 3, v1
    v_lshlrev_b32 v8, 13, v8
    v_and_b32 v9, 7, v1
    v_lshlrev_b32 v9, 4, v9
    v_add_u32 v8, v8, v9
    buffer_load_dwordx4 a[0:3], v8, s[16:19], s58 offen nt
    s_add_u32 s58, s58, 65536
    buffer_load_dwordx4 a[4:7], v8, s[16:19], s58 offen nt
    s_add_u32 s58, s58, 65536
    buffer_load_dwordx4 a[8:11], v8, s[16:19], s58 offen nt
    s_add_u32 s58, s58, 65536
    buffer_load_dwordx4 a[12:15], v8, s[16:19], s58 offen nt
    s_barrier
    s_lshl_b32 s58, s3, 16
    s_lshl_b32 s59, s4, 14
    s_add_u32 s58, s58, s59
    s_add_u32 s59, s59, 65536
    s_mul_i32 s62, s3, 5
    s_lshl_b32 s63, s4, 2
    s_add_u32 s62, s62, s63
    s_lshr_b32 s63, s3, 4
    s_add_u32 s62, s62, s63
    s_and_b32 s62, s62, 15
    s_and_b32 s63, s62, 3
    s_lshl_b32 s63, s63, 2
    s_lshr_b32 s64, s62, 2
    s_or_b32 s63, s63, s64
    v_xor_b32 v8, s63, v1
    v_lshlrev_b32 v8, 4, v8
    s_lshl_b32 s64, s62, 10
    s_add_u32 s65, s59, s64
    s_mov_b32 m0, s65
    s_add_u32 s65, s58, s64
    buffer_load_dwordx4 v8, s[12:15], s65 offen nt lds
    s_add_u32 s62, s62, 1
    s_and_b32 s62, s62, 15
    s_and_b32 s63, s62, 3
    s_lshl_b32 s63, s63, 2
    s_lshr_b32 s64, s62, 2
    s_or_b32 s63, s63, s64
    v_xor_b32 v8, s63, v1
    v_lshlrev_b32 v8, 4, v8
    s_lshl_b32 s64, s62, 10
    s_add_u32 s65, s59, s64
    s_mov_b32 m0, s65
    s_add_u32 s65, s58, s64
    buffer_load_dwordx4 v8, s[12:15], s65 offen nt lds
    s_add_u32 s62, s62, 1
    s_and_b32 s62, s62, 15
    s_and_b32 s63, s62, 3
    s_lshl_b32 s63, s63, 2
    s_lshr_b32 s64, s62, 2
    s_or_b32 s63, s63, s64
    v_xor_b32 v8, s63, v1
    v_lshlrev_b32 v8, 4, v8
    s_lshl_b32 s64, s62, 10
    s_add_u32 s65, s59, s64
    s_mov_b32 m0, s65
    s_add_u32 s65, s58, s64
    buffer_load_dwordx4 v8, s[12:15], s65 offen nt lds
    s_add_u32 s62, s62, 1
    s_and_b32 s62, s62, 15
    s_and_b32 s63, s62, 3
    s_lshl_b32 s63, s63, 2
    s_lshr_b32 s64, s62, 2
    s_or_b32 s63, s63, s64
    v_xor_b32 v8, s63, v1
    v_lshlrev_b32 v8, 4, v8
    s_lshl_b32 s64, s62, 10
    s_add_u32 s65, s59, s64
    s_mov_b32 m0, s65
    s_add_u32 s65, s58, s64
    buffer_load_dwordx4 v8, s[12:15], s65 offen nt lds
    s_add_u32 s62, s62, 1
    s_and_b32 s62, s62, 15
    s_and_b32 s63, s62, 3
    s_lshl_b32 s63, s63, 2
    s_lshr_b32 s64, s62, 2
    s_or_b32 s63, s63, s64
    v_xor_b32 v8, s63, v1
    v_lshlrev_b32 v8, 4, v8
    s_lshl_b32 s64, s62, 10
    s_add_u32 s65, s59, s64
    s_mov_b32 m0, s65
    s_add_u32 s65, s58, s64
    buffer_load_dwordx4 v8, s[12:15], s65 offen nt lds
    s_add_u32 s62, s62, 1
    s_and_b32 s62, s62, 15
    s_and_b32 s63, s62, 3
    s_lshl_b32 s63, s63, 2
    s_lshr_b32 s64, s62, 2
    s_or_b32 s63, s63, s64
    v_xor_b32 v8, s63, v1
    v_lshlrev_b32 v8, 4, v8
    s_lshl_b32 s64, s62, 10
    s_add_u32 s65, s59, s64
    s_mov_b32 m0, s65
    s_add_u32 s65, s58, s64
    buffer_load_dwordx4 v8, s[12:15], s65 offen nt lds
    s_add_u32 s62, s62, 1
    s_and_b32 s62, s62, 15
    s_and_b32 s63, s62, 3
    s_lshl_b32 s63, s63, 2
    s_lshr_b32 s64, s62, 2
    s_or_b32 s63, s63, s64
    v_xor_b32 v8, s63, v1
    v_lshlrev_b32 v8, 4, v8
    s_lshl_b32 s64, s62, 10
    s_add_u32 s65, s59, s64
    s_mov_b32 m0, s65
    s_add_u32 s65, s58, s64
    buffer_load_dwordx4 v8, s[12:15], s65 offen nt lds
    s_add_u32 s62, s62, 1
    s_and_b32 s62, s62, 15
    s_and_b32 s63, s62, 3
    s_lshl_b32 s63, s63, 2
    s_lshr_b32 s64, s62, 2
    s_or_b32 s63, s63, s64
    v_xor_b32 v8, s63, v1
    v_lshlrev_b32 v8, 4, v8
    s_lshl_b32 s64, s62, 10
    s_add_u32 s65, s59, s64
    s_mov_b32 m0, s65
    s_add_u32 s65, s58, s64
    buffer_load_dwordx4 v8, s[12:15], s65 offen nt lds
    s_add_u32 s62, s62, 1
    s_and_b32 s62, s62, 15
    s_and_b32 s63, s62, 3
    s_lshl_b32 s63, s63, 2
    s_lshr_b32 s64, s62, 2
    s_or_b32 s63, s63, s64
    v_xor_b32 v8, s63, v1
    v_lshlrev_b32 v8, 4, v8
    s_lshl_b32 s64, s62, 10
    s_add_u32 s65, s59, s64
    s_mov_b32 m0, s65
    s_add_u32 s65, s58, s64
    buffer_load_dwordx4 v8, s[12:15], s65 offen nt lds
    s_add_u32 s62, s62, 1
    s_and_b32 s62, s62, 15
    s_and_b32 s63, s62, 3
    s_lshl_b32 s63, s63, 2
    s_lshr_b32 s64, s62, 2
    s_or_b32 s63, s63, s64
    v_xor_b32 v8, s63, v1
    v_lshlrev_b32 v8, 4, v8
    s_lshl_b32 s64, s62, 10
    s_add_u32 s65, s59, s64
    s_mov_b32 m0, s65
    s_add_u32 s65, s58, s64
    buffer_load_dwordx4 v8, s[12:15], s65 offen nt lds
    s_add_u32 s62, s62, 1
    s_and_b32 s62, s62, 15
    s_and_b32 s63, s62, 3
    s_lshl_b32 s63, s63, 2
    s_lshr_b32 s64, s62, 2
    s_or_b32 s63, s63, s64
    v_xor_b32 v8, s63, v1
    v_lshlrev_b32 v8, 4, v8
    s_lshl_b32 s64, s62, 10
    s_add_u32 s65, s59, s64
    s_mov_b32 m0, s65
    s_add_u32 s65, s58, s64
    buffer_load_dwordx4 v8, s[12:15], s65 offen nt lds
    s_add_u32 s62, s62, 1
    s_and_b32 s62, s62, 15
    s_and_b32 s63, s62, 3
    s_lshl_b32 s63, s63, 2
    s_lshr_b32 s64, s62, 2
    s_or_b32 s63, s63, s64
    v_xor_b32 v8, s63, v1
    v_lshlrev_b32 v8, 4, v8
    s_lshl_b32 s64, s62, 10
    s_add_u32 s65, s59, s64
    s_mov_b32 m0, s65
    s_add_u32 s65, s58, s64
    buffer_load_dwordx4 v8, s[12:15], s65 offen nt lds
    s_add_u32 s62, s62, 1
    s_and_b32 s62, s62, 15
    s_and_b32 s63, s62, 3
    s_lshl_b32 s63, s63, 2
    s_lshr_b32 s64, s62, 2
    s_or_b32 s63, s63, s64
    v_xor_b32 v8, s63, v1
    v_lshlrev_b32 v8, 4, v8
    s_lshl_b32 s64, s62, 10
    s_add_u32 s65, s59, s64
    s_mov_b32 m0, s65
    s_add_u32 s65, s58, s64
    buffer_load_dwordx4 v8, s[12:15], s65 offen nt lds
    s_add_u32 s62, s62, 1
    s_and_b32 s62, s62, 15
    s_and_b32 s63, s62, 3
    s_lshl_b32 s63, s63, 2
    s_lshr_b32 s64, s62, 2
    s_or_b32 s63, s63, s64
    v_xor_b32 v8, s63, v1
    v_lshlrev_b32 v8, 4, v8
    s_lshl_b32 s64, s62, 10
    s_add_u32 s65, s59, s64
    s_mov_b32 m0, s65
    s_add_u32 s65, s58, s64
    buffer_load_dwordx4 v8, s[12:15], s65 offen nt lds
    s_add_u32 s62, s62, 1
    s_and_b32 s62, s62, 15
    s_and_b32 s63, s62, 3
    s_lshl_b32 s63, s63, 2
    s_lshr_b32 s64, s62, 2
    s_or_b32 s63, s63, s64
    v_xor_b32 v8, s63, v1
    v_lshlrev_b32 v8, 4, v8
    s_lshl_b32 s64, s62, 10
    s_add_u32 s65, s59, s64
    s_mov_b32 m0, s65
    s_add_u32 s65, s58, s64
    buffer_load_dwordx4 v8, s[12:15], s65 offen nt lds
    s_add_u32 s62, s62, 1
    s_and_b32 s62, s62, 15
    s_and_b32 s63, s62, 3
    s_lshl_b32 s63, s63, 2
    s_lshr_b32 s64, s62, 2
    s_or_b32 s63, s63, s64
    v_xor_b32 v8, s63, v1
    v_lshlrev_b32 v8, 4, v8
    s_lshl_b32 s64, s62, 10
    s_add_u32 s65, s59, s64
    s_mov_b32 m0, s65
    s_add_u32 s65, s58, s64
    buffer_load_dwordx4 v8, s[12:15], s65 offen nt lds
    s_add_u32 s62, s62, 1
    s_waitcnt vmcnt(16)
    v_lshlrev_b32 v4, 16, v6
    v_and_b32 v5, 0xffff0000, v6
    v_lshlrev_b32 v6, 16, v7
    v_and_b32 v7, 0xffff0000, v7
L_ALOOP:
    v_add_f32 v16, v4, v5
    v_add_f32 v17, v6, v7
    v_add_f32 v16, v16, v17
    s_nop 1
    v_add_f32_dpp v16, v16, v16 row_shr:1 row_mask:0xf bank_mask:0xf
    s_nop 1
    v_add_f32_dpp v16, v16, v16 row_shr:2 row_mask:0xf bank_mask:0xf
    s_nop 1
    v_add_f32_dpp v16, v16, v16 row_shr:4 row_mask:0xf bank_mask:0xf
    s_nop 1
    v_add_f32_dpp v16, v16, v16 row_shr:8 row_mask:0xf bank_mask:0xf
    s_nop 1
    v_add_f32_dpp v16, v16, v16 row_bcast:15 row_mask:0xa bank_mask:0xf
    s_nop 1
    v_add_f32_dpp v16, v16, v16 row_bcast:31 row_mask:0xc bank_mask:0xf
    s_lshl_b32 s58, s4, 2
    v_mov_b32 v9, s58
    s_and_b32 s59, s58, 8
    v_mov_b32 v10, s59
    v_readlane_b32 s60, v16, 63
    s_nop 1
    v_mov_b32 v17, s60
    ds_write_b32 v9, v17 offset:16384
    s_waitcnt lgkmcnt(0)
    s_barrier
    ds_read_b64 v[16:17], v10 offset:16384
    v_mov_b32 v22, 0x3b000000
    s_waitcnt lgkmcnt(0)
    v_add_f32 v16, v16, v17
    v_mul_f32 v20, v16, v22
    v_sub_f32 v24, v4, v20
    v_sub_f32 v25, v5, v20
    v_sub_f32 v26, v6, v20
    v_sub_f32 v27, v7, v20
    v_mul_f32 v16, v24, v24
    v_mul_f32 v17, v26, v26
    v_fmac_f32 v16, v25, v25
    v_fmac_f32 v17, v27, v27
    v_add_f32 v16, v16, v17
    s_nop 1
    v_add_f32_dpp v16, v16, v16 row_shr:1 row_mask:0xf bank_mask:0xf
    s_nop 1
    v_add_f32_dpp v16, v16, v16 row_shr:2 row_mask:0xf bank_mask:0xf
    s_nop 1
    v_add_f32_dpp v16, v16, v16 row_shr:4 row_mask:0xf bank_mask:0xf
    s_nop 1
    v_add_f32_dpp v16, v16, v16 row_shr:8 row_mask:0xf bank_mask:0xf
    s_nop 1
    v_add_f32_dpp v16, v16, v16 row_bcast:15 row_mask:0xa bank_mask:0xf
    s_nop 1
    v_add_f32_dpp v16, v16, v16 row_bcast:31 row_mask:0xc bank_mask:0xf
    v_cvt_pk_bf16_f32 v20, v20, v20
    v_lshlrev_b32 v20, 16, v20
    v_readlane_b32 s60, v16, 63
    s_nop 1
    v_mov_b32 v17, s60
    ds_write_b32 v9, v17 offset:16400
    v_sub_f32 v24, v4, v20
    v_sub_f32 v25, v5, v20
    v_sub_f32 v26, v6, v20
    v_sub_f32 v27, v7, v20
    v_cvt_pk_bf16_f32 v24, v24, v24
    v_lshlrev_b32 v24, 16, v24
    v_cvt_pk_bf16_f32 v25, v25, v25
    v_lshlrev_b32 v25, 16, v25
    v_cvt_pk_bf16_f32 v26, v26, v26
    v_lshlrev_b32 v26, 16, v26
    v_cvt_pk_bf16_f32 v27, v27, v27
    v_lshlrev_b32 v27, 16, v27
    s_waitcnt lgkmcnt(0)
    s_barrier
    ds_read_b64 v[16:17], v10 offset:16400
    v_lshlrev_b32 v8, 4, v0
    s_waitcnt lgkmcnt(0)
    v_add_f32 v16, v16, v17
    v_mul_f32 v16, v16, v22
    v_cvt_pk_bf16_f32 v16, v16, v16
    v_lshlrev_b32 v16, 16, v16
    v_add_f32 v16, 0x3727c5ac, v16
    v_cvt_pk_bf16_f32 v16, v16, v16
    v_lshlrev_b32 v16, 16, v16
    v_sqrt_f32 v16, v16
    s_nop 0
    v_cvt_pk_bf16_f32 v16, v16, v16
    v_lshlrev_b32 v16, 16, v16
    v_rcp_f32 v17, v16
    s_nop 0
    v_fma_f32 v18, -v16, v17, 2.0
    v_mul_f32 v17, v17, v18
    v_mul_f32 v24, v24, v17
    v_mul_f32 v25, v25, v17
    v_mul_f32 v26, v26, v17
    v_mul_f32 v27, v27, v17
    v_cvt_pk_bf16_f32 v24, v24, v24
    v_lshlrev_b32 v24, 16, v24
    v_cvt_pk_bf16_f32 v25, v25, v25
    v_lshlrev_b32 v25, 16, v25
    v_cvt_pk_bf16_f32 v26, v26, v26
    v_lshlrev_b32 v26, 16, v26
    v_cvt_pk_bf16_f32 v27, v27, v27
    v_lshlrev_b32 v27, 16, v27
    ds_write_b128 v8, v[24:27] offset:0
    s_waitcnt lgkmcnt(0)
    s_barrier
    s_and_b32 s58, s3, 3
    s_lshl_b32 s58, s58, 2
    s_add_u32 s58, s58, s4
    s_lshl_b32 s58, s58, 7
    v_lshrrev_b32 v8, 3, v1
    v_lshlrev_b32 v8, 2, v8
    v_add_u32 v8, s58, v8
    ds_read_b32 v16, v8 offset:0
    ds_read_b32 v17, v8 offset:2048
    ds_read_b32 v18, v8 offset:32
    ds_read_b32 v19, v8 offset:2080
    ds_read_b32 v20, v8 offset:64
    ds_read_b32 v21, v8 offset:2112
    ds_read_b32 v22, v8 offset:96
    ds_read_b32 v23, v8 offset:2144
    v_mov_b32 v32, 0
    v_mov_b32 v33, 0
    v_mov_b32 v34, 0
    v_mov_b32 v35, 0
    v_mov_b32 v36, 0
    v_mov_b32 v37, 0
    v_mov_b32 v38, 0
    v_mov_b32 v39, 0
    v_mov_b32 v40, 0
    v_mov_b32 v41, 0
    v_mov_b32 v42, 0
    v_mov_b32 v43, 0
    v_mov_b32 v44, 0
    v_mov_b32 v45, 0
    v_mov_b32 v46, 0
    v_mov_b32 v47, 0
    s_waitcnt lgkmcnt(0)
    v_accvgpr_read_b32 v24, a0
    v_lshlrev_b32 v25, 16, v24
    v_and_b32 v26, 0xffff0000, v24
    v_fmac_f32 v32, v16, v25
    v_fmac_f32 v33, v16, v26
    v_fmac_f32 v40, v17, v25
    v_fmac_f32 v41, v17, v26
    v_accvgpr_read_b32 v24, a1
    v_lshlrev_b32 v25, 16, v24
    v_and_b32 v26, 0xffff0000, v24
    v_fmac_f32 v34, v16, v25
    v_fmac_f32 v35, v16, v26
    v_fmac_f32 v42, v17, v25
    v_fmac_f32 v43, v17, v26
    v_accvgpr_read_b32 v24, a2
    v_lshlrev_b32 v25, 16, v24
    v_and_b32 v26, 0xffff0000, v24
    v_fmac_f32 v36, v16, v25
    v_fmac_f32 v37, v16, v26
    v_fmac_f32 v44, v17, v25
    v_fmac_f32 v45, v17, v26
    v_accvgpr_read_b32 v24, a3
    v_lshlrev_b32 v25, 16, v24
    v_and_b32 v26, 0xffff0000, v24
    v_fmac_f32 v38, v16, v25
    v_fmac_f32 v39, v16, v26
    v_fmac_f32 v46, v17, v25
    v_fmac_f32 v47, v17, v26
    v_accvgpr_read_b32 v24, a4
    v_lshlrev_b32 v25, 16, v24
    v_and_b32 v26, 0xffff0000, v24
    v_fmac_f32 v32, v18, v25
    v_fmac_f32 v33, v18, v26
    v_fmac_f32 v40, v19, v25
    v_fmac_f32 v41, v19, v26
    v_accvgpr_read_b32 v24, a5
    v_lshlrev_b32 v25, 16, v24
    v_and_b32 v26, 0xffff0000, v24
    v_fmac_f32 v34, v18, v25
    v_fmac_f32 v35, v18, v26
    v_fmac_f32 v42, v19, v25
    v_fmac_f32 v43, v19, v26
    v_accvgpr_read_b32 v24, a6
    v_lshlrev_b32 v25, 16, v24
    v_and_b32 v26, 0xffff0000, v24
    v_fmac_f32 v36, v18, v25
    v_fmac_f32 v37, v18, v26
    v_fmac_f32 v44, v19, v25
    v_fmac_f32 v45, v19, v26
    v_accvgpr_read_b32 v24, a7
    v_lshlrev_b32 v25, 16, v24
    v_and_b32 v26, 0xffff0000, v24
    v_fmac_f32 v38, v18, v25
    v_fmac_f32 v39, v18, v26
    v_fmac_f32 v46, v19, v25
    v_fmac_f32 v47, v19, v26
    v_accvgpr_read_b32 v24, a8
    v_lshlrev_b32 v25, 16, v24
    v_and_b32 v26, 0xffff0000, v24
    v_fmac_f32 v32, v20, v25
    v_fmac_f32 v33, v20, v26
    v_fmac_f32 v40, v21, v25
    v_fmac_f32 v41, v21, v26
    v_accvgpr_read_b32 v24, a9
    v_lshlrev_b32 v25, 16, v24
    v_and_b32 v26, 0xffff0000, v24
    v_fmac_f32 v34, v20, v25
    v_fmac_f32 v35, v20, v26
    v_fmac_f32 v42, v21, v25
    v_fmac_f32 v43, v21, v26
    v_accvgpr_read_b32 v24, a10
    v_lshlrev_b32 v25, 16, v24
    v_and_b32 v26, 0xffff0000, v24
    v_fmac_f32 v36, v20, v25
    v_fmac_f32 v37, v20, v26
    v_fmac_f32 v44, v21, v25
    v_fmac_f32 v45, v21, v26
    v_accvgpr_read_b32 v24, a11
    v_lshlrev_b32 v25, 16, v24
    v_and_b32 v26, 0xffff0000, v24
    v_fmac_f32 v38, v20, v25
    v_fmac_f32 v39, v20, v26
    v_fmac_f32 v46, v21, v25
    v_fmac_f32 v47, v21, v26
    v_accvgpr_read_b32 v24, a12
    v_lshlrev_b32 v25, 16, v24
    v_and_b32 v26, 0xffff0000, v24
    v_fmac_f32 v32, v22, v25
    v_fmac_f32 v33, v22, v26
    v_fmac_f32 v40, v23, v25
    v_fmac_f32 v41, v23, v26
    v_accvgpr_read_b32 v24, a13
    v_lshlrev_b32 v25, 16, v24
    v_and_b32 v26, 0xffff0000, v24
    v_fmac_f32 v34, v22, v25
    v_fmac_f32 v35, v22, v26
    v_fmac_f32 v42, v23, v25
    v_fmac_f32 v43, v23, v26
    v_accvgpr_read_b32 v24, a14
    v_lshlrev_b32 v25, 16, v24
    v_and_b32 v26, 0xffff0000, v24
    v_fmac_f32 v36, v22, v25
    v_fmac_f32 v37, v22, v26
    v_fmac_f32 v44, v23, v25
    v_fmac_f32 v45, v23, v26
    v_accvgpr_read_b32 v24, a15
    v_lshlrev_b32 v25, 16, v24
    v_and_b32 v26, 0xffff0000, v24
    v_fmac_f32 v38, v22, v25
    v_fmac_f32 v39, v22, v26
    v_fmac_f32 v46, v23, v25
    v_fmac_f32 v47, v23, v26
    v_permlane32_swap_b32 v32, v40
    v_add_f32 v32, v32, v40
    v_permlane32_swap_b32 v33, v41
    v_add_f32 v33, v33, v41
    v_permlane32_swap_b32 v34, v42
    v_add_f32 v34, v34, v42
    v_permlane32_swap_b32 v35, v43
    v_add_f32 v35, v35, v43
    v_permlane32_swap_b32 v36, v44
    v_add_f32 v36, v36, v44
    v_permlane32_swap_b32 v37, v45
    v_add_f32 v37, v37, v45
    v_permlane32_swap_b32 v38, v46
    v_add_f32 v38, v38, v46
    v_permlane32_swap_b32 v39, v47
    v_add_f32 v39, v39, v47
    v_permlane16_swap_b32 v32, v36
    v_add_f32 v32, v32, v36
    v_permlane16_swap_b32 v33, v37
    v_add_f32 v33, v33, v37
    v_permlane16_swap_b32 v34, v38
    v_add_f32 v34, v34, v38
    v_permlane16_swap_b32 v35, v39
    v_add_f32 v35, v35, v39
    v_add_f32_dpp v32, v32, v32 row_ror:8 row_mask:0xf bank_mask:0xf
    v_add_f32_dpp v33, v33, v33 row_ror:8 row_mask:0xf bank_mask:0xf
    v_add_f32_dpp v34, v34, v34 row_ror:8 row_mask:0xf bank_mask:0xf
    v_add_f32_dpp v35, v35, v35 row_ror:8 row_mask:0xf bank_mask:0xf
    v_and_b32 v8, 7, v1
    v_lshlrev_b32 v8, 5, v8
    v_lshrrev_b32 v9, 4, v1
    v_and_b32 v9, 1, v9
    v_lshlrev_b32 v9, 4, v9
    v_add_u32 v8, v8, v9
    v_lshrrev_b32 v9, 5, v1
    v_lshlrev_b32 v9, 8, v9
    v_add_u32 v8, v8, v9
    s_lshl_b32 s58, s4, 9
    v_add_u32 v8, s58, v8
    ds_write_b128 v8, v[32:35] offset:53248
    s_waitcnt lgkmcnt(0)
    s_barrier
    s_and_b32 s58, s4, 1
    s_lshl_b32 s58, s58, 8
    v_add_u32 v8, s58, v2
    ds_read_b32 v16, v8 offset:53248
    ds_read_b32 v17, v8 offset:53760
    ds_read_b32 v18, v8 offset:54272
    ds_read_b32 v19, v8 offset:54784
    s_waitcnt lgkmcnt(0)
    v_add_f32 v16, v16, v17
    v_add_f32 v18, v18, v19
    v_add_f32 v16, v16, v18
    v_min_u32 v16, -2, v16
    s_cmp_ge_u32 s4, 2
    s_cbranch_scc1 LS_1
    s_and_b32 s58, s3, 3
    s_lshl_b32 s58, s58, 1
    s_add_u32 s58, s58, s4
    s_lshl_b32 s58, s58, 14
    s_lshr_b32 s59, s3, 2
    s_lshl_b32 s59, s59, 8
    s_add_u32 s58, s58, s59
    s_add_u32 s58, s58, s5
    s_cmp_eq_u32 s7, 1
    s_cbranch_scc1 LF_2
    buffer_store_dword v16, v2, s[52:55], s58 offen sc1
    s_branch LE_3
LF_2:
    buffer_store_dword v16, v2, s[52:55], s58 offen
LE_3:
LS_1:
    s_barrier
    s_barrier
    s_lshl_b32 s58, s56, 15
    s_lshl_b32 s59, s4, 13
    s_add_u32 s58, s58, s59
    s_add_u32 s58, s58, s5
    s_add_u32 s58, s58, 12582912
    s_add_u32 s62, s58, 4096
LP_4:
    buffer_load_dwordx4 v[16:19], v3, s[52:55], s58 offen sc1
    buffer_load_dwordx4 v[20:23], v3, s[52:55], s58 offen offset:1024 sc1
    buffer_load_dwordx4 v[24:27], v3, s[52:55], s58 offen offset:2048 sc1
    buffer_load_dwordx4 v[28:31], v3, s[52:55], s58 offen offset:3072 sc1
    buffer_load_dwordx4 v[32:35], v3, s[52:55], s62 offen sc1
    buffer_load_dwordx4 v[36:39], v3, s[52:55], s62 offen offset:1024 sc1
    buffer_load_dwordx4 v[40:43], v3, s[52:55], s62 offen offset:2048 sc1
    buffer_load_dwordx4 v[44:47], v3, s[52:55], s62 offen offset:3072 sc1
    s_waitcnt vmcnt(0)
    v_max3_u32 v8, v16, v17, v18
    v_max3_u32 v8, v8, v19, v20
    v_max3_u32 v8, v8, v21, v22
    v_max3_u32 v8, v8, v23, v24
    v_max3_u32 v8, v8, v25, v26
    v_max3_u32 v8, v8, v27, v28
    v_max3_u32 v8, v8, v29, v30
    v_max3_u32 v8, v8, v31, v32
    v_max3_u32 v8, v8, v33, v34
    v_max3_u32 v8, v8, v35, v36
    v_max3_u32 v8, v8, v37, v38
    v_max3_u32 v8, v8, v39, v40
    v_max3_u32 v8, v8, v41, v42
    v_max3_u32 v8, v8, v43, v44
    v_max3_u32 v8, v8, v45, v46
    v_max_u32 v8, v8, v47
    v_cmp_eq_u32 vcc, -1, v8
    s_cbranch_vccz LD_5
    s_cmp_eq_u32 s6, 0
    s_cbranch_scc1 LD_5
    s_sub_u32 s6, s6, 1
    s_branch LP_4
LD_5:
    v_and_b32 v8, 3, v1
    v_lshlrev_b32 v8, 2, v8
    v_lshrrev_b32 v9, 2, v1
    v_and_b32 v9, 3, v9
    v_or_b32 v8, v8, v9
    v_lshrrev_b32 v9, 4, v1
    v_xor_b32 v8, v8, v9
    v_lshlrev_b32 v8, 4, v8
    v_and_b32 v9, 15, v1
    v_lshlrev_b32 v9, 10, v9
    v_or_b32 v8, v8, v9
    s_lshl_b32 s58, s4, 8
    s_or_b32 s58, s58, 65536
    v_or_b32 v8, s58, v8
    v_xor_b32 v72, 0, v8
    v_xor_b32 v73, 64, v8
    v_xor_b32 v74, 128, v8
    v_xor_b32 v75, 192, v8
    s_barrier
    v_mov_b32 v9, 0
    ds_read_b32 v8, v9 offset:59136
    s_waitcnt lgkmcnt(0)
    v_readfirstlane_b32 s7, v8
    ds_read_b128 v[80:83], v72 offset:0
    ds_read_b128 v[84:87], v73 offset:0
    ds_read_b128 v[88:91], v74 offset:0
    ds_read_b128 v[92:95], v75 offset:0
    v_add_u32 v9, s59, v3
    ds_read_b128 v[96:99], v72 offset:16384
    ds_read_b128 v[100:103], v73 offset:16384
    ds_read_b128 v[104:107], v74 offset:16384
    ds_read_b128 v[108:111], v75 offset:16384
    s_waitcnt lgkmcnt(4)
    v_mfma_f32_16x16x32_bf16 v[112:115], v[80:83], v[16:19], 0
    v_mfma_f32_16x16x32_bf16 v[116:119], v[80:83], v[20:23], 0
    v_mfma_f32_16x16x32_bf16 v[112:115], v[84:87], v[24:27], v[112:115]
    v_mfma_f32_16x16x32_bf16 v[116:119], v[84:87], v[28:31], v[116:119]
    v_mfma_f32_16x16x32_bf16 v[112:115], v[88:91], v[32:35], v[112:115]
    v_mfma_f32_16x16x32_bf16 v[116:119], v[88:91], v[36:39], v[116:119]
    v_mfma_f32_16x16x32_bf16 v[112:115], v[92:95], v[40:43], v[112:115]
    v_mfma_f32_16x16x32_bf16 v[116:119], v[92:95], v[44:47], v[116:119]
    ds_read_b128 v[80:83], v72 offset:32768
    ds_read_b128 v[84:87], v73 offset:32768
    ds_read_b128 v[88:91], v74 offset:32768
    ds_read_b128 v[92:95], v75 offset:32768
    s_waitcnt lgkmcnt(4)
    v_mfma_f32_16x16x32_bf16 v[120:123], v[96:99], v[16:19], 0
    v_mfma_f32_16x16x32_bf16 v[124:127], v[96:99], v[20:23], 0
    v_mfma_f32_16x16x32_bf16 v[120:123], v[100:103], v[24:27], v[120:123]
    v_mfma_f32_16x16x32_bf16 v[124:127], v[100:103], v[28:31], v[124:127]
    v_mfma_f32_16x16x32_bf16 v[120:123], v[104:107], v[32:35], v[120:123]
    v_mfma_f32_16x16x32_bf16 v[124:127], v[104:107], v[36:39], v[124:127]
    v_mfma_f32_16x16x32_bf16 v[120:123], v[108:111], v[40:43], v[120:123]
    v_mfma_f32_16x16x32_bf16 v[124:127], v[108:111], v[44:47], v[124:127]
    ds_write_b128 v9, v[112:115] offset:20480
    ds_write_b128 v9, v[116:119] offset:21504
    ds_read_b128 v[96:99], v72 offset:49152
    ds_read_b128 v[100:103], v73 offset:49152
    ds_read_b128 v[104:107], v74 offset:49152
    ds_read_b128 v[108:111], v75 offset:49152
    s_waitcnt lgkmcnt(6)
    v_mfma_f32_16x16x32_bf16 v[128:131], v[80:83], v[16:19], 0
    v_mfma_f32_16x16x32_bf16 v[132:135], v[80:83], v[20:23], 0
    v_mfma_f32_16x16x32_bf16 v[128:131], v[84:87], v[24:27], v[128:131]
    v_mfma_f32_16x16x32_bf16 v[132:135], v[84:87], v[28:31], v[132:135]
    v_mfma_f32_16x16x32_bf16 v[128:131], v[88:91], v[32:35], v[128:131]
    v_mfma_f32_16x16x32_bf16 v[132:135], v[88:91], v[36:39], v[132:135]
    v_mfma_f32_16x16x32_bf16 v[128:131], v[92:95], v[40:43], v[128:131]
    v_mfma_f32_16x16x32_bf16 v[132:135], v[92:95], v[44:47], v[132:135]
    ds_write_b128 v9, v[120:123] offset:22528
    ds_write_b128 v9, v[124:127] offset:23552
    s_waitcnt lgkmcnt(2)
    v_mfma_f32_16x16x32_bf16 v[136:139], v[96:99], v[16:19], 0
    v_mfma_f32_16x16x32_bf16 v[140:143], v[96:99], v[20:23], 0
    v_mfma_f32_16x16x32_bf16 v[136:139], v[100:103], v[24:27], v[136:139]
    v_mfma_f32_16x16x32_bf16 v[140:143], v[100:103], v[28:31], v[140:143]
    v_mfma_f32_16x16x32_bf16 v[136:139], v[104:107], v[32:35], v[136:139]
    v_mfma_f32_16x16x32_bf16 v[140:143], v[104:107], v[36:39], v[140:143]
    v_mfma_f32_16x16x32_bf16 v[136:139], v[108:111], v[40:43], v[136:139]
    v_mfma_f32_16x16x32_bf16 v[140:143], v[108:111], v[44:47], v[140:143]
    ds_write_b128 v9, v[128:131] offset:24576
    ds_write_b128 v9, v[132:135] offset:25600
    s_nop 4
    ds_write_b128 v9, v[136:139] offset:26624
    ds_write_b128 v9, v[140:143] offset:27648
    s_lshl_b32 s58, s4, 11
    v_add_u32 v9, s58, v3
    s_waitcnt lgkmcnt(0)
    s_barrier
    ds_read_b128 v[16:19], v9 offset:20480
    ds_read_b128 v[20:23], v9 offset:21504
    ds_read_b128 v[24:27], v9 offset:28672
    ds_read_b128 v[28:31], v9 offset:29696
    ds_read_b128 v[32:35], v9 offset:36864
    ds_read_b128 v[36:39], v9 offset:37888
    ds_read_b128 v[40:43], v9 offset:45056
    ds_read_b128 v[44:47], v9 offset:46080
    s_waitcnt lgkmcnt(0)
    v_add_f32 v16, v16, v24
    v_add_f32 v32, v32, v40
    v_add_f32 v17, v17, v25
    v_add_f32 v33, v33, v41
    v_add_f32 v18, v18, v26
    v_add_f32 v34, v34, v42
    v_add_f32 v19, v19, v27
    v_add_f32 v35, v35, v43
    v_add_f32 v20, v20, v28
    v_add_f32 v36, v36, v44
    v_add_f32 v21, v21, v29
    v_add_f32 v37, v37, v45
    v_add_f32 v22, v22, v30
    v_add_f32 v38, v38, v46
    v_add_f32 v23, v23, v31
    v_add_f32 v39, v39, v47
    v_add_f32 v64, v16, v32
    v_add_f32 v65, v17, v33
    v_add_f32 v66, v18, v34
    v_add_f32 v67, v19, v35
    v_add_f32 v68, v20, v36
    v_add_f32 v69, v21, v37
    v_add_f32 v70, v22, v38
    v_add_f32 v71, v23, v39
    v_and_b32 v8, 15, v1
    v_lshlrev_b32 v8, 4, v8
    s_lshl_b32 s58, s4, 2
    v_add_u32 v9, s58, v8
    v_max3_f32 v10, v64, v65, v66
    v_max3_f32 v11, v68, v69, v70
    v_max_f32 v10, v10, v67
    v_max_f32 v11, v11, v71
    v_mov_b32 v12, v10
    s_nop 1
    v_permlane16_swap_b32 v10, v12
    v_max_f32 v10, v10, v12
    v_mov_b32 v13, v11
    s_nop 1
    v_permlane16_swap_b32 v11, v13
    v_max_f32 v11, v11, v13
    v_mov_b32 v12, v10
    s_nop 1
    v_permlane32_swap_b32 v10, v12
    v_max_f32 v10, v10, v12
    v_mov_b32 v13, v11
    s_nop 1
    v_permlane32_swap_b32 v11, v13
    v_max_f32 v11, v11, v13
    ds_write_b32 v9, v10 offset:59392
    ds_write_b32 v9, v11 offset:59648
    s_waitcnt lgkmcnt(0)
    s_barrier
    ds_read_b128 v[16:19], v8 offset:59392
    ds_read_b128 v[20:23], v8 offset:59648
    v_and_b32 v14, 15, v1
    v_mul_u32_u24 v14, 144, v14
    v_lshrrev_b32 v15, 4, v1
    v_lshlrev_b32 v15, 3, v15
    v_add_u32 v14, v14, v15
    s_lshl_b32 s58, s4, 5
    v_add_u32 v14, s58, v14
    s_waitcnt lgkmcnt(0)
    v_max3_f32 v10, v16, v17, v18
    v_max3_f32 v11, v20, v21, v22
    v_max_f32 v10, v10, v19
    v_max_f32 v11, v11, v23
    v_sub_f32 v64, v64, v10
    v_sub_f32 v65, v65, v10
    v_sub_f32 v66, v66, v10
    v_sub_f32 v67, v67, v10
    v_sub_f32 v68, v68, v11
    v_sub_f32 v69, v69, v11
    v_sub_f32 v70, v70, v11
    v_sub_f32 v71, v71, v11
    v_exp_f32 v64, v64
    v_exp_f32 v65, v65
    v_exp_f32 v66, v66
    v_exp_f32 v67, v67
    v_exp_f32 v68, v68
    v_exp_f32 v69, v69
    v_exp_f32 v70, v70
    v_exp_f32 v71, v71
    v_cvt_pk_bf16_f32 v16, v64, v65
    v_cvt_pk_bf16_f32 v17, v66, v67
    v_cvt_pk_bf16_f32 v18, v68, v69
    v_cvt_pk_bf16_f32 v19, v70, v71
    ds_write_b64 v14, v[16:17] offset:60416
    ds_write_b64 v14, v[18:19] offset:62720
    v_add_f32 v10, v64, v65
    v_add_f32 v12, v66, v67
    v_add_f32 v11, v68, v69
    v_add_f32 v13, v70, v71
    v_add_f32 v10, v10, v12
    v_add_f32 v11, v11, v13
    v_mov_b32 v12, v10
    s_nop 1
    v_permlane16_swap_b32 v10, v12
    v_add_f32 v10, v10, v12
    v_mov_b32 v13, v11
    s_nop 1
    v_permlane16_swap_b32 v11, v13
    v_add_f32 v11, v11, v13
    v_mov_b32 v12, v10
    s_nop 1
    v_permlane32_swap_b32 v10, v12
    v_add_f32 v10, v10, v12
    v_mov_b32 v13, v11
    s_nop 1
    v_permlane32_swap_b32 v11, v13
    v_add_f32 v11, v11, v13
    ds_write_b32 v9, v10 offset:59904
    ds_write_b32 v9, v11 offset:60160
    v_and_b32 v9, 15, v1
    v_lshrrev_b32 v9, 2, v9
    v_lshrrev_b32 v11, 5, v1
    v_lshlrev_b32 v8, 3, v11
    v_add_u32 v8, v8, v9
    v_lshlrev_b32 v8, 10, v8
    v_lshlrev_b32 v9, 6, v9
    v_or_b32 v8, v8, v9
    v_lshrrev_b32 v9, 4, v1
    v_xor_b32 v9, v9, v11
    v_and_b32 v9, 1, v9
    v_lshlrev_b32 v9, 5, v9
    v_or_b32 v8, v8, v9
    v_and_b32 v9, 2, v1
    v_lshlrev_b32 v9, 3, v9
    v_or_b32 v8, v8, v9
    v_and_b32 v9, 1, v1
    v_lshlrev_b32 v9, 3, v9
    v_or_b32 v8, v8, v9
    s_lshl_b32 s58, s4, 8
    s_or_b32 s58, s58, 65536
    v_or_b32 v8, s58, v8
    v_xor_b32 v72, 0x0, v8
    v_xor_b32 v73, 0x1010, v8
    v_xor_b32 v74, 0x40, v8
    v_xor_b32 v75, 0x1050, v8
    v_xor_b32 v76, 0x80, v8
    v_xor_b32 v77, 0x1090, v8
    v_xor_b32 v78, 0xc0, v8
    v_xor_b32 v79, 0x10d0, v8
    v_and_b32 v9, 31, v1
    v_mul_u32_u24 v9, 144, v9
    v_lshlrev_b32 v11, 4, v11
    v_add_u32 v9, v9, v11
    s_waitcnt lgkmcnt(0)
    s_barrier
    ds_read_b128 v[16:19], v9 offset:60416
    ds_read_b128 v[20:23], v9 offset:60448
    ds_read_b128 v[24:27], v9 offset:60480
    ds_read_b128 v[28:31], v9 offset:60512
    v_and_b32 v8, 31, v1
    v_lshlrev_b32 v8, 4, v8
    ds_read_b128 v[48:51], v8 offset:59392
    ds_read_b128 v[52:55], v8 offset:59904
    s_lshl_b32 s58, s3, 15
    s_lshl_b32 s59, s4, 10
    s_add_u32 s58, s58, s59
    s_add_u32 s58, s58, 4194304
    s_add_u32 s59, s58, 8192
    s_add_u32 s62, s58, 16384
    s_add_u32 s63, s58, 24576
    v_lshrrev_b32 v8, 5, v1
    v_lshlrev_b32 v8, 12, v8
    v_and_b32 v9, 31, v1
    v_lshlrev_b32 v9, 3, v9
    v_add_u32 v8, v8, v9
    ds_read_b64_tr_b16 v[80:81], v72 offset:0
    ds_read_b64_tr_b16 v[82:83], v73 offset:0
    ds_read_b64_tr_b16 v[84:85], v72 offset:16384
    ds_read_b64_tr_b16 v[86:87], v73 offset:16384
    ds_read_b64_tr_b16 v[88:89], v72 offset:32768
    ds_read_b64_tr_b16 v[90:91], v73 offset:32768
    ds_read_b64_tr_b16 v[92:93], v72 offset:49152
    ds_read_b64_tr_b16 v[94:95], v73 offset:49152
    ds_read_b64_tr_b16 v[96:97], v74 offset:0
    ds_read_b64_tr_b16 v[98:99], v75 offset:0
    ds_read_b64_tr_b16 v[100:101], v74 offset:16384
    ds_read_b64_tr_b16 v[102:103], v75 offset:16384
    ds_read_b64_tr_b16 v[104:105], v74 offset:32768
    ds_read_b64_tr_b16 v[106:107], v75 offset:32768
    ds_read_b64_tr_b16 v[108:109], v74 offset:49152
    ds_read_b64_tr_b16 v[110:111], v75 offset:49152
    s_waitcnt lgkmcnt(8)
    v_mfma_f32_32x32x16_bf16 v[112:127], v[16:19], v[80:83], 0
    v_mfma_f32_32x32x16_bf16 v[112:127], v[20:23], v[84:87], v[112:127]
    v_mfma_f32_32x32x16_bf16 v[112:127], v[24:27], v[88:91], v[112:127]
    v_mfma_f32_32x32x16_bf16 v[112:127], v[28:31], v[92:95], v[112:127]
    ds_read_b64_tr_b16 v[80:81], v76 offset:0
    ds_read_b64_tr_b16 v[82:83], v77 offset:0
    ds_read_b64_tr_b16 v[84:85], v76 offset:16384
    ds_read_b64_tr_b16 v[86:87], v77 offset:16384
    ds_read_b64_tr_b16 v[88:89], v76 offset:32768
    ds_read_b64_tr_b16 v[90:91], v77 offset:32768
    ds_read_b64_tr_b16 v[92:93], v76 offset:49152
    ds_read_b64_tr_b16 v[94:95], v77 offset:49152
    s_waitcnt lgkmcnt(8)
    v_mfma_f32_32x32x16_bf16 v[128:143], v[16:19], v[96:99], 0
    v_mfma_f32_32x32x16_bf16 v[128:143], v[20:23], v[100:103], v[128:143]
    s_nop 0
    v_cvt_pk_bf16_f32 v32, v112, v113
    v_cvt_pk_bf16_f32 v33, v114, v115
    v_cvt_pk_bf16_f32 v34, v116, v117
    v_cvt_pk_bf16_f32 v35, v118, v119
    v_cvt_pk_bf16_f32 v36, v120, v121
    v_cvt_pk_bf16_f32 v37, v122, v123
    v_cvt_pk_bf16_f32 v38, v124, v125
    v_cvt_pk_bf16_f32 v39, v126, v127
    s_cmp_eq_u32 s7, 1
    s_cbranch_scc1 LF_6
    buffer_store_dwordx2 v[32:33], v8, s[52:55], s58 offen sc1
    buffer_store_dwordx2 v[34:35], v8, s[52:55], s59 offen sc1
    buffer_store_dwordx2 v[36:37], v8, s[52:55], s62 offen sc1
    buffer_store_dwordx2 v[38:39], v8, s[52:55], s63 offen sc1
    s_branch LE_7
LF_6:
    buffer_store_dwordx2 v[32:33], v8, s[52:55], s58 offen
    buffer_store_dwordx2 v[34:35], v8, s[52:55], s59 offen
    buffer_store_dwordx2 v[36:37], v8, s[52:55], s62 offen
    buffer_store_dwordx2 v[38:39], v8, s[52:55], s63 offen
LE_7:
    v_mfma_f32_32x32x16_bf16 v[128:143], v[24:27], v[104:107], v[128:143]
    v_mfma_f32_32x32x16_bf16 v[128:143], v[28:31], v[108:111], v[128:143]
    ds_read_b64_tr_b16 v[96:97], v78 offset:0
    ds_read_b64_tr_b16 v[98:99], v79 offset:0
    ds_read_b64_tr_b16 v[100:101], v78 offset:16384
    ds_read_b64_tr_b16 v[102:103], v79 offset:16384
    ds_read_b64_tr_b16 v[104:105], v78 offset:32768
    ds_read_b64_tr_b16 v[106:107], v79 offset:32768
    ds_read_b64_tr_b16 v[108:109], v78 offset:49152
    ds_read_b64_tr_b16 v[110:111], v79 offset:49152
    s_waitcnt lgkmcnt(8)
    v_mfma_f32_32x32x16_bf16 v[144:159], v[16:19], v[80:83], 0
    v_mfma_f32_32x32x16_bf16 v[144:159], v[20:23], v[84:87], v[144:159]
    s_nop 0
    v_cvt_pk_bf16_f32 v40, v128, v129
    v_cvt_pk_bf16_f32 v41, v130, v131
    v_cvt_pk_bf16_f32 v42, v132, v133
    v_cvt_pk_bf16_f32 v43, v134, v135
    v_cvt_pk_bf16_f32 v44, v136, v137
    v_cvt_pk_bf16_f32 v45, v138, v139
    v_cvt_pk_bf16_f32 v46, v140, v141
    v_cvt_pk_bf16_f32 v47, v142, v143
    s_cmp_eq_u32 s7, 1
    s_cbranch_scc1 LF_8
    buffer_store_dwordx2 v[40:41], v8, s[52:55], s58 offen offset:256 sc1
    buffer_store_dwordx2 v[42:43], v8, s[52:55], s59 offen offset:256 sc1
    buffer_store_dwordx2 v[44:45], v8, s[52:55], s62 offen offset:256 sc1
    buffer_store_dwordx2 v[46:47], v8, s[52:55], s63 offen offset:256 sc1
    s_branch LE_9
LF_8:
    buffer_store_dwordx2 v[40:41], v8, s[52:55], s58 offen offset:256
    buffer_store_dwordx2 v[42:43], v8, s[52:55], s59 offen offset:256
    buffer_store_dwordx2 v[44:45], v8, s[52:55], s62 offen offset:256
    buffer_store_dwordx2 v[46:47], v8, s[52:55], s63 offen offset:256
LE_9:
    v_mfma_f32_32x32x16_bf16 v[144:159], v[24:27], v[88:91], v[144:159]
    v_mfma_f32_32x32x16_bf16 v[144:159], v[28:31], v[92:95], v[144:159]
    s_waitcnt lgkmcnt(0)
    v_mfma_f32_32x32x16_bf16 v[160:175], v[16:19], v[96:99], 0
    v_mfma_f32_32x32x16_bf16 v[160:175], v[20:23], v[100:103], v[160:175]
    s_nop 8
    v_cvt_pk_bf16_f32 v32, v144, v145
    v_cvt_pk_bf16_f32 v33, v146, v147
    v_cvt_pk_bf16_f32 v34, v148, v149
    v_cvt_pk_bf16_f32 v35, v150, v151
    v_cvt_pk_bf16_f32 v36, v152, v153
    v_cvt_pk_bf16_f32 v37, v154, v155
    v_cvt_pk_bf16_f32 v38, v156, v157
    v_cvt_pk_bf16_f32 v39, v158, v159
    s_cmp_eq_u32 s7, 1
    s_cbranch_scc1 LF_10
    buffer_store_dwordx2 v[32:33], v8, s[52:55], s58 offen offset:512 sc1
    buffer_store_dwordx2 v[34:35], v8, s[52:55], s59 offen offset:512 sc1
    buffer_store_dwordx2 v[36:37], v8, s[52:55], s62 offen offset:512 sc1
    buffer_store_dwordx2 v[38:39], v8, s[52:55], s63 offen offset:512 sc1
    s_branch LE_11
LF_10:
    buffer_store_dwordx2 v[32:33], v8, s[52:55], s58 offen offset:512
    buffer_store_dwordx2 v[34:35], v8, s[52:55], s59 offen offset:512
    buffer_store_dwordx2 v[36:37], v8, s[52:55], s62 offen offset:512
    buffer_store_dwordx2 v[38:39], v8, s[52:55], s63 offen offset:512
LE_11:
    v_mfma_f32_32x32x16_bf16 v[160:175], v[24:27], v[104:107], v[160:175]
    v_mfma_f32_32x32x16_bf16 v[160:175], v[28:31], v[108:111], v[160:175]
    s_nop 11
    v_cvt_pk_bf16_f32 v40, v160, v161
    v_cvt_pk_bf16_f32 v41, v162, v163
    v_cvt_pk_bf16_f32 v42, v164, v165
    v_cvt_pk_bf16_f32 v43, v166, v167
    v_cvt_pk_bf16_f32 v44, v168, v169
    v_cvt_pk_bf16_f32 v45, v170, v171
    v_cvt_pk_bf16_f32 v46, v172, v173
    v_cvt_pk_bf16_f32 v47, v174, v175
    s_cmp_eq_u32 s7, 1
    s_cbranch_scc1 LF_12
    buffer_store_dwordx2 v[40:41], v8, s[52:55], s58 offen offset:768 sc1
    buffer_store_dwordx2 v[42:43], v8, s[52:55], s59 offen offset:768 sc1
    buffer_store_dwordx2 v[44:45], v8, s[52:55], s62 offen offset:768 sc1
    buffer_store_dwordx2 v[46:47], v8, s[52:55], s63 offen offset:768 sc1
    s_branch LE_13
LF_12:
    buffer_store_dwordx2 v[40:41], v8, s[52:55], s58 offen offset:768
    buffer_store_dwordx2 v[42:43], v8, s[52:55], s59 offen offset:768
    buffer_store_dwordx2 v[44:45], v8, s[52:55], s62 offen offset:768
    buffer_store_dwordx2 v[46:47], v8, s[52:55], s63 offen offset:768
LE_13:
    s_waitcnt lgkmcnt(0)
    v_max3_f32 v10, v48, v49, v50
    v_max_f32 v10, v10, v51
    v_add_f32 v12, v52, v53
    v_add_f32 v13, v54, v55
    v_add_f32 v12, v12, v13
    v_cmp_gt_u32 vcc, 32, v1
    s_nop 1
    v_cndmask_b32 v13, v12, v10, vcc
    v_min_u32 v13, -2, v13
    s_waitcnt vmcnt(0)
    s_barrier
    s_cmp_lg_u32 s4, 0
    s_cbranch_scc1 LS_14
    s_lshr_b32 s58, s3, 7
    s_lshl_b32 s58, s58, 15
    s_and_b32 s59, s3, 127
    s_lshl_b32 s59, s59, 5
    s_add_u32 s58, s58, s59
    s_add_u32 s58, s58, s5
    s_add_u32 s58, s58, 196608
    v_and_b32 v8, 31, v1
    v_lshrrev_b32 v9, 2, v8
    v_lshlrev_b32 v9, 12, v9
    v_and_b32 v8, 3, v8
    v_lshlrev_b32 v8, 2, v8
    v_add_u32 v8, v8, v9
    v_lshrrev_b32 v9, 5, v1
    v_lshlrev_b32 v9, 4, v9
    v_add_u32 v8, v8, v9
    s_cmp_eq_u32 s7, 1
    s_cbranch_scc1 LF_15
    buffer_store_dword v13, v8, s[52:55], s58 offen sc1
    s_branch LE_16
LF_15:
    buffer_store_dword v13, v8, s[52:55], s58 offen
LE_16:
LS_14:
    s_lshr_b32 s58, s56, 2
    s_lshl_b32 s58, s58, 3
    s_lshr_b32 s59, s57, 2
    s_add_u32 s58, s58, s59
    s_lshl_b32 s58, s58, 12
    s_and_b32 s62, s56, 3
    s_lshl_b32 s62, s62, 10
    s_add_u32 s58, s58, s62
    s_add_u32 s58, s58, s5
    s_add_u32 s58, s58, 196608
    v_and_b32 v9, 31, v1
    v_lshlrev_b32 v9, 5, v9
    s_lshl_b32 s62, s56, 5
    s_lshl_b32 s63, s4, 3
    s_add_u32 s62, s62, s63
    s_lshl_b32 s62, s62, 15
    s_lshl_b32 s59, s59, 12
    s_add_u32 s62, s62, s59
    s_and_b32 s59, s57, 3
    s_lshl_b32 s59, s59, 10
    s_add_u32 s62, s62, s59
    s_add_u32 s64, s62, 4194304
    s_add_u32 s65, s64, 32768
    s_add_u32 s66, s64, 65536
    s_add_u32 s67, s64, 98304
    s_add_u32 s68, s64, 131072
    s_add_u32 s69, s64, 163840
    s_add_u32 s70, s64, 196608
    s_add_u32 s71, s64, 229376
LP_17:
    buffer_load_dwordx4 v[16:19], v9, s[52:55], s58 offen sc1
    buffer_load_dwordx4 v[20:23], v9, s[52:55], s58 offen offset:16 sc1
    s_waitcnt vmcnt(0)
    v_max3_u32 v8, v16, v17, v18
    v_max3_u32 v8, v8, v19, v20
    v_max3_u32 v8, v8, v21, v22
    v_max_u32 v8, v8, v23
    v_cmp_eq_u32 vcc, -1, v8
    s_cbranch_vccz LD_18
    s_cmp_eq_u32 s6, 0
    s_cbranch_scc1 LD_18
    s_sub_u32 s6, s6, 1
    s_branch LP_17
LD_18:
    buffer_load_dwordx4 v[24:27], v3, s[52:55], s64 offen sc1
    buffer_load_dwordx4 v[28:31], v3, s[52:55], s65 offen sc1
    buffer_load_dwordx4 v[32:35], v3, s[52:55], s66 offen sc1
    buffer_load_dwordx4 v[36:39], v3, s[52:55], s67 offen sc1
    buffer_load_dwordx4 v[40:43], v3, s[52:55], s68 offen sc1
    buffer_load_dwordx4 v[44:47], v3, s[52:55], s69 offen sc1
    buffer_load_dwordx4 v[48:51], v3, s[52:55], s70 offen sc1
    buffer_load_dwordx4 v[52:55], v3, s[52:55], s71 offen sc1
    v_mov_b32 v56, v16
    v_mov_b32 v57, v17
    v_mov_b32 v58, v18
    v_mov_b32 v59, v19
    v_max_f32_dpp v56, v56, v56 row_shr:1 row_mask:0xf bank_mask:0xf
    v_max_f32_dpp v57, v57, v57 row_shr:1 row_mask:0xf bank_mask:0xf
    v_max_f32_dpp v58, v58, v58 row_shr:1 row_mask:0xf bank_mask:0xf
    v_max_f32_dpp v59, v59, v59 row_shr:1 row_mask:0xf bank_mask:0xf
    v_max_f32_dpp v56, v56, v56 row_shr:2 row_mask:0xf bank_mask:0xf
    v_max_f32_dpp v57, v57, v57 row_shr:2 row_mask:0xf bank_mask:0xf
    v_max_f32_dpp v58, v58, v58 row_shr:2 row_mask:0xf bank_mask:0xf
    v_max_f32_dpp v59, v59, v59 row_shr:2 row_mask:0xf bank_mask:0xf
    v_max_f32_dpp v56, v56, v56 row_shr:4 row_mask:0xf bank_mask:0xf
    v_max_f32_dpp v57, v57, v57 row_shr:4 row_mask:0xf bank_mask:0xf
    v_max_f32_dpp v58, v58, v58 row_shr:4 row_mask:0xf bank_mask:0xf
    v_max_f32_dpp v59, v59, v59 row_shr:4 row_mask:0xf bank_mask:0xf
    v_max_f32_dpp v56, v56, v56 row_shr:8 row_mask:0xf bank_mask:0xf
    v_max_f32_dpp v57, v57, v57 row_shr:8 row_mask:0xf bank_mask:0xf
    v_max_f32_dpp v58, v58, v58 row_shr:8 row_mask:0xf bank_mask:0xf
    v_max_f32_dpp v59, v59, v59 row_shr:8 row_mask:0xf bank_mask:0xf
    v_max_f32_dpp v56, v56, v56 row_bcast:15 row_mask:0xa bank_mask:0xf
    v_max_f32_dpp v57, v57, v57 row_bcast:15 row_mask:0xa bank_mask:0xf
    v_max_f32_dpp v58, v58, v58 row_bcast:15 row_mask:0xa bank_mask:0xf
    v_max_f32_dpp v59, v59, v59 row_bcast:15 row_mask:0xa bank_mask:0xf
    v_max_f32_dpp v56, v56, v56 row_bcast:31 row_mask:0xc bank_mask:0xf
    v_max_f32_dpp v57, v57, v57 row_bcast:31 row_mask:0xc bank_mask:0xf
    v_max_f32_dpp v58, v58, v58 row_bcast:31 row_mask:0xc bank_mask:0xf
    v_max_f32_dpp v59, v59, v59 row_bcast:31 row_mask:0xc bank_mask:0xf
    v_readlane_b32 s72, v56, 63
    v_readlane_b32 s73, v57, 63
    v_readlane_b32 s74, v58, 63
    v_readlane_b32 s75, v59, 63
    v_subrev_f32 v56, s72, v16
    v_subrev_f32 v57, s73, v17
    v_subrev_f32 v58, s74, v18
    v_subrev_f32 v59, s75, v19
    v_exp_f32 v56, v56
    v_exp_f32 v57, v57
    v_exp_f32 v58, v58
    v_exp_f32 v59, v59
    v_mul_f32 v60, v56, v20
    v_mul_f32 v61, v57, v21
    v_mul_f32 v62, v58, v22
    v_mul_f32 v63, v59, v23
    v_add_f32_dpp v60, v60, v60 row_shr:1 row_mask:0xf bank_mask:0xf
    v_add_f32_dpp v61, v61, v61 row_shr:1 row_mask:0xf bank_mask:0xf
    v_add_f32_dpp v62, v62, v62 row_shr:1 row_mask:0xf bank_mask:0xf
    v_add_f32_dpp v63, v63, v63 row_shr:1 row_mask:0xf bank_mask:0xf
    v_add_f32_dpp v60, v60, v60 row_shr:2 row_mask:0xf bank_mask:0xf
    v_add_f32_dpp v61, v61, v61 row_shr:2 row_mask:0xf bank_mask:0xf
    v_add_f32_dpp v62, v62, v62 row_shr:2 row_mask:0xf bank_mask:0xf
    v_add_f32_dpp v63, v63, v63 row_shr:2 row_mask:0xf bank_mask:0xf
    v_add_f32_dpp v60, v60, v60 row_shr:4 row_mask:0xf bank_mask:0xf
    v_add_f32_dpp v61, v61, v61 row_shr:4 row_mask:0xf bank_mask:0xf
    v_add_f32_dpp v62, v62, v62 row_shr:4 row_mask:0xf bank_mask:0xf
    v_add_f32_dpp v63, v63, v63 row_shr:4 row_mask:0xf bank_mask:0xf
    v_add_f32_dpp v60, v60, v60 row_shr:8 row_mask:0xf bank_mask:0xf
    v_add_f32_dpp v61, v61, v61 row_shr:8 row_mask:0xf bank_mask:0xf
    v_add_f32_dpp v62, v62, v62 row_shr:8 row_mask:0xf bank_mask:0xf
    v_add_f32_dpp v63, v63, v63 row_shr:8 row_mask:0xf bank_mask:0xf
    v_add_f32_dpp v60, v60, v60 row_bcast:15 row_mask:0xa bank_mask:0xf
    v_add_f32_dpp v61, v61, v61 row_bcast:15 row_mask:0xa bank_mask:0xf
    v_add_f32_dpp v62, v62, v62 row_bcast:15 row_mask:0xa bank_mask:0xf
    v_add_f32_dpp v63, v63, v63 row_bcast:15 row_mask:0xa bank_mask:0xf
    v_readlane_b32 s76, v60, 31
    v_readlane_b32 s77, v61, 31
    v_readlane_b32 s78, v62, 31
    v_readlane_b32 s79, v63, 31
    v_mov_b32 v64, 0
    v_mov_b32 v65, 0
    v_mov_b32 v66, 0
    v_mov_b32 v67, 0
    v_mov_b32 v68, 0
    v_mov_b32 v69, 0
    v_mov_b32 v70, 0
    v_mov_b32 v71, 0
    s_lshl_b32 s58, s4, 3
    s_waitcnt vmcnt(7)
    v_readlane_b32 s80, v56, s58
    v_readlane_b32 s81, v57, s58
    v_readlane_b32 s82, v58, s58
    v_readlane_b32 s83, v59, s58
    s_add_u32 s58, s58, 1
    v_lshlrev_b32 v10, 16, v24
    v_and_b32 v11, 0xffff0000, v24
    v_fma_f32 v64, s80, v10, v64
    v_fma_f32 v65, s81, v11, v65
    v_lshlrev_b32 v10, 16, v25
    v_and_b32 v11, 0xffff0000, v25
    v_fma_f32 v66, s82, v10, v66
    v_fma_f32 v67, s83, v11, v67
    v_lshlrev_b32 v10, 16, v26
    v_and_b32 v11, 0xffff0000, v26
    v_fma_f32 v68, s80, v10, v68
    v_fma_f32 v69, s81, v11, v69
    v_lshlrev_b32 v10, 16, v27
    v_and_b32 v11, 0xffff0000, v27
    v_fma_f32 v70, s82, v10, v70
    v_fma_f32 v71, s83, v11, v71
    s_waitcnt vmcnt(6)
    v_readlane_b32 s80, v56, s58
    v_readlane_b32 s81, v57, s58
    v_readlane_b32 s82, v58, s58
    v_readlane_b32 s83, v59, s58
    s_add_u32 s58, s58, 1
    v_lshlrev_b32 v10, 16, v28
    v_and_b32 v11, 0xffff0000, v28
    v_fma_f32 v64, s80, v10, v64
    v_fma_f32 v65, s81, v11, v65
    v_lshlrev_b32 v10, 16, v29
    v_and_b32 v11, 0xffff0000, v29
    v_fma_f32 v66, s82, v10, v66
    v_fma_f32 v67, s83, v11, v67
    v_lshlrev_b32 v10, 16, v30
    v_and_b32 v11, 0xffff0000, v30
    v_fma_f32 v68, s80, v10, v68
    v_fma_f32 v69, s81, v11, v69
    v_lshlrev_b32 v10, 16, v31
    v_and_b32 v11, 0xffff0000, v31
    v_fma_f32 v70, s82, v10, v70
    v_fma_f32 v71, s83, v11, v71
    s_waitcnt vmcnt(5)
    v_readlane_b32 s80, v56, s58
    v_readlane_b32 s81, v57, s58
    v_readlane_b32 s82, v58, s58
    v_readlane_b32 s83, v59, s58
    s_add_u32 s58, s58, 1
    v_lshlrev_b32 v10, 16, v32
    v_and_b32 v11, 0xffff0000, v32
    v_fma_f32 v64, s80, v10, v64
    v_fma_f32 v65, s81, v11, v65
    v_lshlrev_b32 v10, 16, v33
    v_and_b32 v11, 0xffff0000, v33
    v_fma_f32 v66, s82, v10, v66
    v_fma_f32 v67, s83, v11, v67
    v_lshlrev_b32 v10, 16, v34
    v_and_b32 v11, 0xffff0000, v34
    v_fma_f32 v68, s80, v10, v68
    v_fma_f32 v69, s81, v11, v69
    v_lshlrev_b32 v10, 16, v35
    v_and_b32 v11, 0xffff0000, v35
    v_fma_f32 v70, s82, v10, v70
    v_fma_f32 v71, s83, v11, v71
    s_waitcnt vmcnt(4)
    v_readlane_b32 s80, v56, s58
    v_readlane_b32 s81, v57, s58
    v_readlane_b32 s82, v58, s58
    v_readlane_b32 s83, v59, s58
    s_add_u32 s58, s58, 1
    v_lshlrev_b32 v10, 16, v36
    v_and_b32 v11, 0xffff0000, v36
    v_fma_f32 v64, s80, v10, v64
    v_fma_f32 v65, s81, v11, v65
    v_lshlrev_b32 v10, 16, v37
    v_and_b32 v11, 0xffff0000, v37
    v_fma_f32 v66, s82, v10, v66
    v_fma_f32 v67, s83, v11, v67
    v_lshlrev_b32 v10, 16, v38
    v_and_b32 v11, 0xffff0000, v38
    v_fma_f32 v68, s80, v10, v68
    v_fma_f32 v69, s81, v11, v69
    v_lshlrev_b32 v10, 16, v39
    v_and_b32 v11, 0xffff0000, v39
    v_fma_f32 v70, s82, v10, v70
    v_fma_f32 v71, s83, v11, v71
    s_waitcnt vmcnt(3)
    v_readlane_b32 s80, v56, s58
    v_readlane_b32 s81, v57, s58
    v_readlane_b32 s82, v58, s58
    v_readlane_b32 s83, v59, s58
    s_add_u32 s58, s58, 1
    v_lshlrev_b32 v10, 16, v40
    v_and_b32 v11, 0xffff0000, v40
    v_fma_f32 v64, s80, v10, v64
    v_fma_f32 v65, s81, v11, v65
    v_lshlrev_b32 v10, 16, v41
    v_and_b32 v11, 0xffff0000, v41
    v_fma_f32 v66, s82, v10, v66
    v_fma_f32 v67, s83, v11, v67
    v_lshlrev_b32 v10, 16, v42
    v_and_b32 v11, 0xffff0000, v42
    v_fma_f32 v68, s80, v10, v68
    v_fma_f32 v69, s81, v11, v69
    v_lshlrev_b32 v10, 16, v43
    v_and_b32 v11, 0xffff0000, v43
    v_fma_f32 v70, s82, v10, v70
    v_fma_f32 v71, s83, v11, v71
    s_waitcnt vmcnt(2)
    v_readlane_b32 s80, v56, s58
    v_readlane_b32 s81, v57, s58
    v_readlane_b32 s82, v58, s58
    v_readlane_b32 s83, v59, s58
    s_add_u32 s58, s58, 1
    v_lshlrev_b32 v10, 16, v44
    v_and_b32 v11, 0xffff0000, v44
    v_fma_f32 v64, s80, v10, v64
    v_fma_f32 v65, s81, v11, v65
    v_lshlrev_b32 v10, 16, v45
    v_and_b32 v11, 0xffff0000, v45
    v_fma_f32 v66, s82, v10, v66
    v_fma_f32 v67, s83, v11, v67
    v_lshlrev_b32 v10, 16, v46
    v_and_b32 v11, 0xffff0000, v46
    v_fma_f32 v68, s80, v10, v68
    v_fma_f32 v69, s81, v11, v69
    v_lshlrev_b32 v10, 16, v47
    v_and_b32 v11, 0xffff0000, v47
    v_fma_f32 v70, s82, v10, v70
    v_fma_f32 v71, s83, v11, v71
    s_waitcnt vmcnt(1)
    v_readlane_b32 s80, v56, s58
    v_readlane_b32 s81, v57, s58
    v_readlane_b32 s82, v58, s58
    v_readlane_b32 s83, v59, s58
    s_add_u32 s58, s58, 1
    v_lshlrev_b32 v10, 16, v48
    v_and_b32 v11, 0xffff0000, v48
    v_fma_f32 v64, s80, v10, v64
    v_fma_f32 v65, s81, v11, v65
    v_lshlrev_b32 v10, 16, v49
    v_and_b32 v11, 0xffff0000, v49
    v_fma_f32 v66, s82, v10, v66
    v_fma_f32 v67, s83, v11, v67
    v_lshlrev_b32 v10, 16, v50
    v_and_b32 v11, 0xffff0000, v50
    v_fma_f32 v68, s80, v10, v68
    v_fma_f32 v69, s81, v11, v69
    v_lshlrev_b32 v10, 16, v51
    v_and_b32 v11, 0xffff0000, v51
    v_fma_f32 v70, s82, v10, v70
    v_fma_f32 v71, s83, v11, v71
    s_waitcnt vmcnt(0)
    v_readlane_b32 s80, v56, s58
    v_readlane_b32 s81, v57, s58
    v_readlane_b32 s82, v58, s58
    v_readlane_b32 s83, v59, s58
    s_add_u32 s58, s58, 1
    v_lshlrev_b32 v10, 16, v52
    v_and_b32 v11, 0xffff0000, v52
    v_fma_f32 v64, s80, v10, v64
    v_fma_f32 v65, s81, v11, v65
    v_lshlrev_b32 v10, 16, v53
    v_and_b32 v11, 0xffff0000, v53
    v_fma_f32 v66, s82, v10, v66
    v_fma_f32 v67, s83, v11, v67
    v_lshlrev_b32 v10, 16, v54
    v_and_b32 v11, 0xffff0000, v54
    v_fma_f32 v68, s80, v10, v68
    v_fma_f32 v69, s81, v11, v69
    v_lshlrev_b32 v10, 16, v55
    v_and_b32 v11, 0xffff0000, v55
    v_fma_f32 v70, s82, v10, v70
    v_fma_f32 v71, s83, v11, v71
    v_lshlrev_b32 v8, 5, v0
    ds_write_b128 v8, v[64:67] offset:0
    ds_write_b128 v8, v[68:71] offset:16
    s_waitcnt lgkmcnt(0)
    s_barrier
    v_lshlrev_b32 v8, 3, v0
    ds_read_b64 v[16:17], v8 offset:0
    ds_read_b64 v[18:19], v8 offset:2048
    ds_read_b64 v[20:21], v8 offset:4096
    ds_read_b64 v[22:23], v8 offset:6144
    s_waitcnt lgkmcnt(0)
    v_add_f32 v16, v16, v18
    v_add_f32 v20, v20, v22
    v_add_f32 v17, v17, v19
    v_add_f32 v21, v21, v23
    v_add_f32 v16, v16, v20
    v_add_f32 v17, v17, v21
    v_min_u32 v16, -2, v16
    v_min_u32 v17, -2, v17
    s_lshl_b32 s58, s3, 11
    s_add_u32 s58, s58, s5
    s_add_u32 s58, s58, 327680
    v_lshlrev_b32 v8, 3, v0
    buffer_store_dwordx2 v[16:17], v8, s[52:55], s58 offen sc1
    v_mov_b32 v24, s72
    v_mov_b32 v25, s73
    v_mov_b32 v26, s74
    v_mov_b32 v27, s75
    v_mov_b32 v28, s76
    v_mov_b32 v29, s77
    v_mov_b32 v30, s78
    v_mov_b32 v31, s79
    v_min_u32 v24, -2, v24
    v_min_u32 v25, -2, v25
    v_min_u32 v26, -2, v26
    v_min_u32 v27, -2, v27
    v_min_u32 v28, -2, v28
    v_min_u32 v29, -2, v29
    v_min_u32 v30, -2, v30
    v_min_u32 v31, -2, v31
    s_and_b32 s58, s57, 3
    s_or_b32 s58, s58, s4
    s_cmp_lg_u32 s58, 0
    s_cbranch_scc1 LS_19
    s_lshr_b32 s58, s3, 2
    s_lshl_b32 s58, s58, 5
    s_add_u32 s58, s58, s5
    s_add_u32 s58, s58, 262144
    v_mov_b32 v8, 0
    s_mov_b64 exec, 1
    buffer_store_dwordx4 v[24:27], v8, s[52:55], s58 offen sc1
    buffer_store_dwordx4 v[28:31], v8, s[52:55], s58 offen offset:16 sc1
    s_mov_b64 exec, -1
LS_19:
    s_barrier
    s_cmp_lg_u32 s97, 0
    s_cbranch_scc1 LI_20
    s_cmp_ge_u32 s57, 28
    s_cbranch_scc1 LS_21
    s_mul_i32 s62, s56, 28
    s_add_u32 s62, s62, s57
    s_lshl_b32 s58, s62, 4
    s_mul_i32 s59, s4, 229376
    s_add_u32 s58, s58, s59
    s_add_u32 s59, s58, 917504
    s_movk_i32 s63, 3584
    v_mul_lo_u32 v8, v1, s63
    buffer_load_dwordx4 a[16:19], v8, s[32:35], s58 offen
    buffer_load_dwordx4 a[20:23], v8, s[32:35], s59 offen
    buffer_load_dwordx4 a[24:27], v8, s[36:39], s58 offen
    buffer_load_dwordx4 a[28:31], v8, s[36:39], s59 offen
LS_21:
    s_cmp_ge_u32 s57, 28
    s_cbranch_scc1 LS_22
    s_mul_i32 s62, s56, 28
    s_add_u32 s62, s62, s57
    s_lshl_b32 s58, s62, 13
    s_lshl_b32 s59, s4, 8
    s_add_u32 s58, s58, s59
    buffer_load_dword a32, v2, s[40:43], s58 offen nt
    buffer_load_dword a33, v2, s[40:43], s58 offen offset:1024 nt
    buffer_load_dword a34, v2, s[40:43], s58 offen offset:2048 nt
    buffer_load_dword a35, v2, s[40:43], s58 offen offset:3072 nt
    s_add_u32 s58, s58, 4096
    buffer_load_dword a36, v2, s[40:43], s58 offen nt
    buffer_load_dword a37, v2, s[40:43], s58 offen offset:1024 nt
    buffer_load_dword a38, v2, s[40:43], s58 offen offset:2048 nt
    buffer_load_dword a39, v2, s[40:43], s58 offen offset:3072 nt
LS_22:
LI_20:
    s_barrier
    s_barrier
    s_barrier
    s_cmp_lg_u32 s4, 0
    s_cbranch_scc1 LS_23
    s_lshl_b32 s58, s57, 7
    s_add_u32 s58, s58, s5
    s_add_u32 s58, s58, 851968
    v_lshrrev_b32 v9, 3, v1
    v_lshlrev_b32 v9, 12, v9
    v_and_b32 v10, 7, v1
    v_lshlrev_b32 v10, 4, v10
    v_add_u32 v9, v9, v10
LP_24:
    buffer_load_dwordx4 v[16:19], v9, s[52:55], s58 offen sc1
    s_waitcnt vmcnt(0)
    v_max3_u32 v8, v16, v17, v18
    v_max_u32 v8, v8, v19
    v_cmp_eq_u32 vcc, -1, v8
    s_cbranch_vccz LD_25
    s_cmp_eq_u32 s6, 0
    s_cbranch_scc1 LD_25
    s_sub_u32 s6, s6, 1
    s_branch LP_24
LD_25:
    v_add_f32_dpp v16, v16, v16 row_ror:8 row_mask:0xf bank_mask:0xf
    v_add_f32_dpp v17, v17, v17 row_ror:8 row_mask:0xf bank_mask:0xf
    v_add_f32_dpp v18, v18, v18 row_ror:8 row_mask:0xf bank_mask:0xf
    v_add_f32_dpp v19, v19, v19 row_ror:8 row_mask:0xf bank_mask:0xf
    v_mov_b32 v20, v16
    s_nop 1
    v_permlane16_swap_b32 v16, v20
    v_add_f32 v16, v16, v20
    v_mov_b32 v21, v17
    s_nop 1
    v_permlane16_swap_b32 v17, v21
    v_add_f32 v17, v17, v21
    v_mov_b32 v22, v18
    s_nop 1
    v_permlane16_swap_b32 v18, v22
    v_add_f32 v18, v18, v22
    v_mov_b32 v23, v19
    s_nop 1
    v_permlane16_swap_b32 v19, v23
    v_add_f32 v19, v19, v23
    v_mov_b32 v20, v16
    s_nop 1
    v_permlane32_swap_b32 v16, v20
    v_add_f32 v16, v16, v20
    v_mov_b32 v21, v17
    s_nop 1
    v_permlane32_swap_b32 v17, v21
    v_add_f32 v17, v17, v21
    v_mov_b32 v22, v18
    s_nop 1
    v_permlane32_swap_b32 v18, v22
    v_add_f32 v18, v18, v22
    v_mov_b32 v23, v19
    s_nop 1
    v_permlane32_swap_b32 v19, v23
    v_add_f32 v19, v19, v23
    v_min_u32 v16, -2, v16
    v_min_u32 v17, -2, v17
    v_min_u32 v18, -2, v18
    v_min_u32 v19, -2, v19
    s_lshl_b32 s58, s3, 7
    s_add_u32 s58, s58, s5
    s_add_u32 s58, s58, 13107200
    s_mov_b64 exec, 0xff
    s_cmp_eq_u32 s7, 1
    s_cbranch_scc1 LF_26
    buffer_store_dwordx4 v[16:19], v3, s[52:55], s58 offen sc1
    s_branch LE_27
LF_26:
    buffer_store_dwordx4 v[16:19], v3, s[52:55], s58 offen
LE_27:
    s_mov_b64 exec, -1
LS_23:
    s_lshl_b32 s58, s56, 12
    s_lshl_b32 s59, s4, 10
    s_add_u32 s58, s58, s59
    s_add_u32 s58, s58, s5
    s_add_u32 s58, s58, 13107200
LP_28:
    buffer_load_dwordx4 v[16:19], v3, s[52:55], s58 offen sc1
    s_waitcnt vmcnt(0)
    v_max3_u32 v8, v16, v17, v18
    v_max_u32 v8, v8, v19
    v_cmp_eq_u32 vcc, -1, v8
    s_cbranch_vccz LD_29
    s_cmp_eq_u32 s6, 0
    s_cbranch_scc1 LD_29
    s_sub_u32 s6, s6, 1
    s_branch LP_28
LD_29:
    v_cvt_pk_bf16_f32 v16, v16, v16
    v_lshlrev_b32 v16, 16, v16
    v_cvt_pk_bf16_f32 v17, v17, v17
    v_lshlrev_b32 v17, 16, v17
    v_cvt_pk_bf16_f32 v18, v18, v18
    v_lshlrev_b32 v18, 16, v18
    v_cvt_pk_bf16_f32 v19, v19, v19
    v_lshlrev_b32 v19, 16, v19
    v_add_f32 v4, v4, v16
    v_add_f32 v5, v5, v17
    v_add_f32 v6, v6, v18
    v_add_f32 v7, v7, v19
    v_cvt_pk_bf16_f32 v4, v4, v4
    v_lshlrev_b32 v4, 16, v4
    v_cvt_pk_bf16_f32 v5, v5, v5
    v_lshlrev_b32 v5, 16, v5
    v_cvt_pk_bf16_f32 v6, v6, v6
    v_lshlrev_b32 v6, 16, v6
    v_cvt_pk_bf16_f32 v7, v7, v7
    v_lshlrev_b32 v7, 16, v7
    v_add_f32 v16, v4, v5
    v_add_f32 v17, v6, v7
    v_add_f32 v16, v16, v17
    s_nop 1
    v_add_f32_dpp v16, v16, v16 row_shr:1 row_mask:0xf bank_mask:0xf
    s_nop 1
    v_add_f32_dpp v16, v16, v16 row_shr:2 row_mask:0xf bank_mask:0xf
    s_nop 1
    v_add_f32_dpp v16, v16, v16 row_shr:4 row_mask:0xf bank_mask:0xf
    s_nop 1
    v_add_f32_dpp v16, v16, v16 row_shr:8 row_mask:0xf bank_mask:0xf
    s_nop 1
    v_add_f32_dpp v16, v16, v16 row_bcast:15 row_mask:0xa bank_mask:0xf
    s_nop 1
    v_add_f32_dpp v16, v16, v16 row_bcast:31 row_mask:0xc bank_mask:0xf
    s_lshl_b32 s58, s4, 2
    v_mov_b32 v9, s58
    s_and_b32 s59, s58, 8
    v_mov_b32 v10, s59
    v_readlane_b32 s60, v16, 63
    s_nop 1
    v_mov_b32 v17, s60
    ds_write_b32 v9, v17 offset:16384
    s_waitcnt lgkmcnt(0)
    s_barrier
    ds_read_b64 v[16:17], v10 offset:16384
    v_mov_b32 v22, 0x3b000000
    s_waitcnt lgkmcnt(0)
    v_add_f32 v16, v16, v17
    v_mul_f32 v20, v16, v22
    v_sub_f32 v24, v4, v20
    v_sub_f32 v25, v5, v20
    v_sub_f32 v26, v6, v20
    v_sub_f32 v27, v7, v20
    v_mul_f32 v16, v24, v24
    v_mul_f32 v17, v26, v26
    v_fmac_f32 v16, v25, v25
    v_fmac_f32 v17, v27, v27
    v_add_f32 v16, v16, v17
    s_nop 1
    v_add_f32_dpp v16, v16, v16 row_shr:1 row_mask:0xf bank_mask:0xf
    s_nop 1
    v_add_f32_dpp v16, v16, v16 row_shr:2 row_mask:0xf bank_mask:0xf
    s_nop 1
    v_add_f32_dpp v16, v16, v16 row_shr:4 row_mask:0xf bank_mask:0xf
    s_nop 1
    v_add_f32_dpp v16, v16, v16 row_shr:8 row_mask:0xf bank_mask:0xf
    s_nop 1
    v_add_f32_dpp v16, v16, v16 row_bcast:15 row_mask:0xa bank_mask:0xf
    s_nop 1
    v_add_f32_dpp v16, v16, v16 row_bcast:31 row_mask:0xc bank_mask:0xf
    v_cvt_pk_bf16_f32 v20, v20, v20
    v_lshlrev_b32 v20, 16, v20
    v_readlane_b32 s60, v16, 63
    s_nop 1
    v_mov_b32 v17, s60
    ds_write_b32 v9, v17 offset:16400
    v_sub_f32 v24, v4, v20
    v_sub_f32 v25, v5, v20
    v_sub_f32 v26, v6, v20
    v_sub_f32 v27, v7, v20
    v_cvt_pk_bf16_f32 v24, v24, v24
    v_lshlrev_b32 v24, 16, v24
    v_cvt_pk_bf16_f32 v25, v25, v25
    v_lshlrev_b32 v25, 16, v25
    v_cvt_pk_bf16_f32 v26, v26, v26
    v_lshlrev_b32 v26, 16, v26
    v_cvt_pk_bf16_f32 v27, v27, v27
    v_lshlrev_b32 v27, 16, v27
    s_waitcnt lgkmcnt(0)
    s_barrier
    ds_read_b64 v[16:17], v10 offset:16400
    v_lshlrev_b32 v8, 4, v0
    s_waitcnt lgkmcnt(0)
    v_add_f32 v16, v16, v17
    v_mul_f32 v16, v16, v22
    v_cvt_pk_bf16_f32 v16, v16, v16
    v_lshlrev_b32 v16, 16, v16
    v_add_f32 v16, 0x3727c5ac, v16
    v_cvt_pk_bf16_f32 v16, v16, v16
    v_lshlrev_b32 v16, 16, v16
    v_sqrt_f32 v16, v16
    s_nop 0
    v_cvt_pk_bf16_f32 v16, v16, v16
    v_lshlrev_b32 v16, 16, v16
    v_rcp_f32 v17, v16
    s_nop 0
    v_fma_f32 v18, -v16, v17, 2.0
    v_mul_f32 v17, v17, v18
    v_mul_f32 v24, v24, v17
    v_mul_f32 v25, v25, v17
    v_mul_f32 v26, v26, v17
    v_mul_f32 v27, v27, v17
    v_cvt_pk_bf16_f32 v24, v24, v24
    v_lshlrev_b32 v24, 16, v24
    v_cvt_pk_bf16_f32 v25, v25, v25
    v_lshlrev_b32 v25, 16, v25
    v_cvt_pk_bf16_f32 v26, v26, v26
    v_lshlrev_b32 v26, 16, v26
    v_cvt_pk_bf16_f32 v27, v27, v27
    v_lshlrev_b32 v27, 16, v27
    ds_write_b128 v8, v[24:27] offset:0
    s_waitcnt lgkmcnt(0)
    s_barrier
    s_cmp_ge_u32 s57, 28
    s_cbranch_scc1 LS_30
    s_lshl_b32 s58, s4, 8
    v_add_u32 v8, s58, v2
    ds_read_b32 v16, v8 offset:0
    ds_read_b32 v17, v8 offset:2048
    ds_read_b32 v18, v8 offset:1024
    ds_read_b32 v19, v8 offset:3072
    v_mov_b32 v32, 0
    v_mov_b32 v33, 0
    v_mov_b32 v34, 0
    v_mov_b32 v35, 0
    v_mov_b32 v36, 0
    v_mov_b32 v37, 0
    v_mov_b32 v38, 0
    v_mov_b32 v39, 0
    v_mov_b32 v40, 0
    v_mov_b32 v41, 0
    v_mov_b32 v42, 0
    v_mov_b32 v43, 0
    v_mov_b32 v44, 0
    v_mov_b32 v45, 0
    v_mov_b32 v46, 0
    v_mov_b32 v47, 0
    v_mov_b32 v48, 0
    v_mov_b32 v49, 0
    v_mov_b32 v50, 0
    v_mov_b32 v51, 0
    v_mov_b32 v52, 0
    v_mov_b32 v53, 0
    v_mov_b32 v54, 0
    v_mov_b32 v55, 0
    v_mov_b32 v56, 0
    v_mov_b32 v57, 0
    v_mov_b32 v58, 0
    v_mov_b32 v59, 0
    v_mov_b32 v60, 0
    v_mov_b32 v61, 0
    v_mov_b32 v62, 0
    v_mov_b32 v63, 0
    s_waitcnt lgkmcnt(0)
    v_accvgpr_read_b32 v24, a16
    v_lshlrev_b32 v25, 16, v24
    v_and_b32 v26, 0xffff0000, v24
    v_fmac_f32 v32, v16, v25
    v_fmac_f32 v33, v16, v26
    v_fmac_f32 v40, v17, v25
    v_fmac_f32 v41, v17, v26
    v_accvgpr_read_b32 v24, a17
    v_lshlrev_b32 v25, 16, v24
    v_and_b32 v26, 0xffff0000, v24
    v_fmac_f32 v34, v16, v25
    v_fmac_f32 v35, v16, v26
    v_fmac_f32 v42, v17, v25
    v_fmac_f32 v43, v17, v26
    v_accvgpr_read_b32 v24, a18
    v_lshlrev_b32 v25, 16, v24
    v_and_b32 v26, 0xffff0000, v24
    v_fmac_f32 v36, v16, v25
    v_fmac_f32 v37, v16, v26
    v_fmac_f32 v44, v17, v25
    v_fmac_f32 v45, v17, v26
    v_accvgpr_read_b32 v24, a19
    v_lshlrev_b32 v25, 16, v24
    v_and_b32 v26, 0xffff0000, v24
    v_fmac_f32 v38, v16, v25
    v_fmac_f32 v39, v16, v26
    v_fmac_f32 v46, v17, v25
    v_fmac_f32 v47, v17, v26
    v_accvgpr_read_b32 v24, a20
    v_lshlrev_b32 v25, 16, v24
    v_and_b32 v26, 0xffff0000, v24
    v_fmac_f32 v32, v18, v25
    v_fmac_f32 v33, v18, v26
    v_fmac_f32 v40, v19, v25
    v_fmac_f32 v41, v19, v26
    v_accvgpr_read_b32 v24, a21
    v_lshlrev_b32 v25, 16, v24
    v_and_b32 v26, 0xffff0000, v24
    v_fmac_f32 v34, v18, v25
    v_fmac_f32 v35, v18, v26
    v_fmac_f32 v42, v19, v25
    v_fmac_f32 v43, v19, v26
    v_accvgpr_read_b32 v24, a22
    v_lshlrev_b32 v25, 16, v24
    v_and_b32 v26, 0xffff0000, v24
    v_fmac_f32 v36, v18, v25
    v_fmac_f32 v37, v18, v26
    v_fmac_f32 v44, v19, v25
    v_fmac_f32 v45, v19, v26
    v_accvgpr_read_b32 v24, a23
    v_lshlrev_b32 v25, 16, v24
    v_and_b32 v26, 0xffff0000, v24
    v_fmac_f32 v38, v18, v25
    v_fmac_f32 v39, v18, v26
    v_fmac_f32 v46, v19, v25
    v_fmac_f32 v47, v19, v26
    v_accvgpr_read_b32 v24, a24
    v_lshlrev_b32 v25, 16, v24
    v_and_b32 v26, 0xffff0000, v24
    v_fmac_f32 v48, v16, v25
    v_fmac_f32 v49, v16, v26
    v_fmac_f32 v56, v17, v25
    v_fmac_f32 v57, v17, v26
    v_accvgpr_read_b32 v24, a25
    v_lshlrev_b32 v25, 16, v24
    v_and_b32 v26, 0xffff0000, v24
    v_fmac_f32 v50, v16, v25
    v_fmac_f32 v51, v16, v26
    v_fmac_f32 v58, v17, v25
    v_fmac_f32 v59, v17, v26
    v_accvgpr_read_b32 v24, a26
    v_lshlrev_b32 v25, 16, v24
    v_and_b32 v26, 0xffff0000, v24
    v_fmac_f32 v52, v16, v25
    v_fmac_f32 v53, v16, v26
    v_fmac_f32 v60, v17, v25
    v_fmac_f32 v61, v17, v26
    v_accvgpr_read_b32 v24, a27
    v_lshlrev_b32 v25, 16, v24
    v_and_b32 v26, 0xffff0000, v24
    v_fmac_f32 v54, v16, v25
    v_fmac_f32 v55, v16, v26
    v_fmac_f32 v62, v17, v25
    v_fmac_f32 v63, v17, v26
    v_accvgpr_read_b32 v24, a28
    v_lshlrev_b32 v25, 16, v24
    v_and_b32 v26, 0xffff0000, v24
    v_fmac_f32 v48, v18, v25
    v_fmac_f32 v49, v18, v26
    v_fmac_f32 v56, v19, v25
    v_fmac_f32 v57, v19, v26
    v_accvgpr_read_b32 v24, a29
    v_lshlrev_b32 v25, 16, v24
    v_and_b32 v26, 0xffff0000, v24
    v_fmac_f32 v50, v18, v25
    v_fmac_f32 v51, v18, v26
    v_fmac_f32 v58, v19, v25
    v_fmac_f32 v59, v19, v26
    v_accvgpr_read_b32 v24, a30
    v_lshlrev_b32 v25, 16, v24
    v_and_b32 v26, 0xffff0000, v24
    v_fmac_f32 v52, v18, v25
    v_fmac_f32 v53, v18, v26
    v_fmac_f32 v60, v19, v25
    v_fmac_f32 v61, v19, v26
    v_accvgpr_read_b32 v24, a31
    v_lshlrev_b32 v25, 16, v24
    v_and_b32 v26, 0xffff0000, v24
    v_fmac_f32 v54, v18, v25
    v_fmac_f32 v55, v18, v26
    v_fmac_f32 v62, v19, v25
    v_fmac_f32 v63, v19, v26
    v_permlane32_swap_b32 v32, v48
    v_add_f32 v32, v32, v48
    v_permlane32_swap_b32 v33, v49
    v_add_f32 v33, v33, v49
    v_permlane32_swap_b32 v34, v50
    v_add_f32 v34, v34, v50
    v_permlane32_swap_b32 v35, v51
    v_add_f32 v35, v35, v51
    v_permlane32_swap_b32 v36, v52
    v_add_f32 v36, v36, v52
    v_permlane32_swap_b32 v37, v53
    v_add_f32 v37, v37, v53
    v_permlane32_swap_b32 v38, v54
    v_add_f32 v38, v38, v54
    v_permlane32_swap_b32 v39, v55
    v_add_f32 v39, v39, v55
    v_permlane32_swap_b32 v40, v56
    v_add_f32 v40, v40, v56
    v_permlane32_swap_b32 v41, v57
    v_add_f32 v41, v41, v57
    v_permlane32_swap_b32 v42, v58
    v_add_f32 v42, v42, v58
    v_permlane32_swap_b32 v43, v59
    v_add_f32 v43, v43, v59
    v_permlane32_swap_b32 v44, v60
    v_add_f32 v44, v44, v60
    v_permlane32_swap_b32 v45, v61
    v_add_f32 v45, v45, v61
    v_permlane32_swap_b32 v46, v62
    v_add_f32 v46, v46, v62
    v_permlane32_swap_b32 v47, v63
    v_add_f32 v47, v47, v63
    v_permlane16_swap_b32 v32, v40
    v_add_f32 v32, v32, v40
    v_permlane16_swap_b32 v33, v41
    v_add_f32 v33, v33, v41
    v_permlane16_swap_b32 v34, v42
    v_add_f32 v34, v34, v42
    v_permlane16_swap_b32 v35, v43
    v_add_f32 v35, v35, v43
    v_permlane16_swap_b32 v36, v44
    v_add_f32 v36, v36, v44
    v_permlane16_swap_b32 v37, v45
    v_add_f32 v37, v37, v45
    v_permlane16_swap_b32 v38, v46
    v_add_f32 v38, v38, v46
    v_permlane16_swap_b32 v39, v47
    v_add_f32 v39, v39, v47
    v_add_f32_dpp v32, v32, v32 row_shr:1 row_mask:0xf bank_mask:0xf
    v_add_f32_dpp v33, v33, v33 row_shr:1 row_mask:0xf bank_mask:0xf
    v_add_f32_dpp v34, v34, v34 row_shr:1 row_mask:0xf bank_mask:0xf
    v_add_f32_dpp v35, v35, v35 row_shr:1 row_mask:0xf bank_mask:0xf
    v_add_f32_dpp v36, v36, v36 row_shr:1 row_mask:0xf bank_mask:0xf
    v_add_f32_dpp v37, v37, v37 row_shr:1 row_mask:0xf bank_mask:0xf
    v_add_f32_dpp v38, v38, v38 row_shr:1 row_mask:0xf bank_mask:0xf
    v_add_f32_dpp v39, v39, v39 row_shr:1 row_mask:0xf bank_mask:0xf
    v_add_f32_dpp v32, v32, v32 row_shr:2 row_mask:0xf bank_mask:0xf
    v_add_f32_dpp v33, v33, v33 row_shr:2 row_mask:0xf bank_mask:0xf
    v_add_f32_dpp v34, v34, v34 row_shr:2 row_mask:0xf bank_mask:0xf
    v_add_f32_dpp v35, v35, v35 row_shr:2 row_mask:0xf bank_mask:0xf
    v_add_f32_dpp v36, v36, v36 row_shr:2 row_mask:0xf bank_mask:0xf
    v_add_f32_dpp v37, v37, v37 row_shr:2 row_mask:0xf bank_mask:0xf
    v_add_f32_dpp v38, v38, v38 row_shr:2 row_mask:0xf bank_mask:0xf
    v_add_f32_dpp v39, v39, v39 row_shr:2 row_mask:0xf bank_mask:0xf
    v_add_f32_dpp v32, v32, v32 row_shr:4 row_mask:0xf bank_mask:0xf
    v_add_f32_dpp v33, v33, v33 row_shr:4 row_mask:0xf bank_mask:0xf
    v_add_f32_dpp v34, v34, v34 row_shr:4 row_mask:0xf bank_mask:0xf
    v_add_f32_dpp v35, v35, v35 row_shr:4 row_mask:0xf bank_mask:0xf
    v_add_f32_dpp v36, v36, v36 row_shr:4 row_mask:0xf bank_mask:0xf
    v_add_f32_dpp v37, v37, v37 row_shr:4 row_mask:0xf bank_mask:0xf
    v_add_f32_dpp v38, v38, v38 row_shr:4 row_mask:0xf bank_mask:0xf
    v_add_f32_dpp v39, v39, v39 row_shr:4 row_mask:0xf bank_mask:0xf
    v_add_f32_dpp v32, v32, v32 row_shr:8 row_mask:0xf bank_mask:0xf
    v_add_f32_dpp v33, v33, v33 row_shr:8 row_mask:0xf bank_mask:0xf
    v_add_f32_dpp v34, v34, v34 row_shr:8 row_mask:0xf bank_mask:0xf
    v_add_f32_dpp v35, v35, v35 row_shr:8 row_mask:0xf bank_mask:0xf
    v_add_f32_dpp v36, v36, v36 row_shr:8 row_mask:0xf bank_mask:0xf
    v_add_f32_dpp v37, v37, v37 row_shr:8 row_mask:0xf bank_mask:0xf
    v_add_f32_dpp v38, v38, v38 row_shr:8 row_mask:0xf bank_mask:0xf
    v_add_f32_dpp v39, v39, v39 row_shr:8 row_mask:0xf bank_mask:0xf
    v_lshrrev_b32 v9, 4, v1
    v_lshlrev_b32 v9, 5, v9
    s_lshl_b32 s58, s4, 7
    v_add_u32 v9, s58, v9
    s_mov_b32 s60, 0x80008000
    s_mov_b32 s61, 0x80008000
    s_mov_b64 exec, s[60:61]
    ds_write_b128 v9, v[32:35] offset:58112
    ds_write_b128 v9, v[36:39] offset:58128
    s_mov_b64 exec, -1
    s_waitcnt lgkmcnt(0)
    s_barrier
    v_and_b32 v9, 15, v1
    v_lshlrev_b32 v9, 2, v9
    ds_read_b32 v16, v9 offset:58112
    ds_read_b32 v20, v9 offset:58176
    ds_read_b32 v17, v9 offset:58240
    ds_read_b32 v21, v9 offset:58304
    ds_read_b32 v18, v9 offset:58368
    ds_read_b32 v22, v9 offset:58432
    ds_read_b32 v19, v9 offset:58496
    ds_read_b32 v23, v9 offset:58560
    s_waitcnt lgkmcnt(0)
    v_add_f32 v16, v16, v17
    v_add_f32 v18, v18, v19
    v_add_f32 v20, v20, v21
    v_add_f32 v22, v22, v23
    v_add_f32 v16, v16, v18
    v_add_f32 v20, v20, v22
    v_cvt_pk_bf16_f32 v16, v16, v16
    v_lshlrev_b32 v16, 16, v16
    v_cvt_pk_bf16_f32 v20, v20, v20
    v_lshlrev_b32 v20, 16, v20
    v_mul_f32 v17, 0xbfb8aa3b, v16
    v_exp_f32 v17, v17
    s_nop 0
    v_add_f32 v17, 1.0, v17
    v_rcp_f32 v17, v17
    s_nop 0
    v_mul_f32 v17, v17, v16
    v_cvt_pk_bf16_f32 v17, v17, v17
    v_lshlrev_b32 v17, 16, v17
    v_mul_f32 v17, v17, v20
    v_cvt_pk_bf16_f32 v17, v17, v17
    v_lshlrev_b32 v17, 16, v17
    s_nop 0
    v_readlane_b32 s64, v17, 0
    v_readlane_b32 s65, v17, 1
    v_readlane_b32 s66, v17, 2
    v_readlane_b32 s67, v17, 3
    v_readlane_b32 s68, v17, 4
    v_readlane_b32 s69, v17, 5
    v_readlane_b32 s70, v17, 6
    v_readlane_b32 s71, v17, 7
    v_readlane_b32 s72, v17, 8
    v_readlane_b32 s73, v17, 9
    v_readlane_b32 s74, v17, 10
    v_readlane_b32 s75, v17, 11
    v_readlane_b32 s76, v17, 12
    v_readlane_b32 s77, v17, 13
    v_readlane_b32 s78, v17, 14
    v_readlane_b32 s79, v17, 15
    v_mov_b32 v24, 0
    v_mov_b32 v25, 0
    v_mov_b32 v26, 0
    v_mov_b32 v27, 0
    v_accvgpr_read_b32 v28, a32
    v_lshlrev_b32 v29, 16, v28
    v_and_b32 v30, 0xffff0000, v28
    v_fma_f32 v24, s64, v29, v24
    v_fma_f32 v25, s64, v30, v25
    v_fma_f32 v26, s72, v29, v26
    v_fma_f32 v27, s72, v30, v27
    v_accvgpr_read_b32 v28, a33
    v_lshlrev_b32 v29, 16, v28
    v_and_b32 v30, 0xffff0000, v28
    v_fma_f32 v24, s65, v29, v24
    v_fma_f32 v25, s65, v30, v25
    v_fma_f32 v26, s73, v29, v26
    v_fma_f32 v27, s73, v30, v27
    v_accvgpr_read_b32 v28, a34
    v_lshlrev_b32 v29, 16, v28
    v_and_b32 v30, 0xffff0000, v28
    v_fma_f32 v24, s66, v29, v24
    v_fma_f32 v25, s66, v30, v25
    v_fma_f32 v26, s74, v29, v26
    v_fma_f32 v27, s74, v30, v27
    v_accvgpr_read_b32 v28, a35
    v_lshlrev_b32 v29, 16, v28
    v_and_b32 v30, 0xffff0000, v28
    v_fma_f32 v24, s67, v29, v24
    v_fma_f32 v25, s67, v30, v25
    v_fma_f32 v26, s75, v29, v26
    v_fma_f32 v27, s75, v30, v27
    v_accvgpr_read_b32 v28, a36
    v_lshlrev_b32 v29, 16, v28
    v_and_b32 v30, 0xffff0000, v28
    v_fma_f32 v24, s68, v29, v24
    v_fma_f32 v25, s68, v30, v25
    v_fma_f32 v26, s76, v29, v26
    v_fma_f32 v27, s76, v30, v27
    v_accvgpr_read_b32 v28, a37
    v_lshlrev_b32 v29, 16, v28
    v_and_b32 v30, 0xffff0000, v28
    v_fma_f32 v24, s69, v29, v24
    v_fma_f32 v25, s69, v30, v25
    v_fma_f32 v26, s77, v29, v26
    v_fma_f32 v27, s77, v30, v27
    v_accvgpr_read_b32 v28, a38
    v_lshlrev_b32 v29, 16, v28
    v_and_b32 v30, 0xffff0000, v28
    v_fma_f32 v24, s70, v29, v24
    v_fma_f32 v25, s70, v30, v25
    v_fma_f32 v26, s78, v29, v26
    v_fma_f32 v27, s78, v30, v27
    v_accvgpr_read_b32 v28, a39
    v_lshlrev_b32 v29, 16, v28
    v_and_b32 v30, 0xffff0000, v28
    v_fma_f32 v24, s71, v29, v24
    v_fma_f32 v25, s71, v30, v25
    v_fma_f32 v26, s79, v29, v26
    v_fma_f32 v27, s79, v30, v27
    v_min_u32 v24, -2, v24
    v_min_u32 v25, -2, v25
    v_min_u32 v26, -2, v26
    v_min_u32 v27, -2, v27
    s_lshl_b32 s58, s3, 12
    s_lshl_b32 s59, s4, 9
    s_add_u32 s58, s58, s59
    s_add_u32 s58, s58, s5
    s_add_u32 s58, s58, 3145728
    v_lshlrev_b32 v8, 3, v1
    s_cmp_eq_u32 s7, 1
    s_cbranch_scc1 LF_31
    buffer_store_dwordx2 v[24:25], v8, s[52:55], s58 offen sc1
    buffer_store_dwordx2 v[26:27], v8, s[52:55], s58 offen offset:2048 sc1
    s_branch LE_32
LF_31:
    buffer_store_dwordx2 v[24:25], v8, s[52:55], s58 offen
    buffer_store_dwordx2 v[26:27], v8, s[52:55], s58 offen offset:2048
LE_32:
    s_branch LS_33
LS_30:
    s_barrier
LS_33:
    s_lshl_b32 s58, s56, 5
    s_lshl_b32 s59, s4, 3
    s_add_u32 s58, s58, s59
    s_lshl_b32 s58, s58, 12
    s_lshl_b32 s59, s57, 7
    s_add_u32 s58, s58, s59
    s_add_u32 s58, s58, s5
    s_add_u32 s58, s58, 3145728
    v_lshrrev_b32 v9, 3, v1
    v_lshlrev_b32 v9, 12, v9
    v_and_b32 v10, 7, v1
    v_lshlrev_b32 v10, 4, v10
    v_add_u32 v9, v9, v10
    v_mov_b32 v16, 0
    v_mov_b32 v17, 0
    v_mov_b32 v18, 0
    v_mov_b32 v19, 0
    v_lshrrev_b32 v10, 3, v0
    v_cmp_gt_u32 s[60:61], 28, v10
LP_34:
    s_nop 0
    s_mov_b64 exec, s[60:61]
    buffer_load_dwordx4 v[16:19], v9, s[52:55], s58 offen sc1
    s_mov_b64 exec, -1
    s_waitcnt vmcnt(0)
    v_max3_u32 v8, v16, v17, v18
    v_max_u32 v8, v8, v19
    v_cmp_eq_u32 vcc, -1, v8
    s_cbranch_vccz LD_35
    s_cmp_eq_u32 s6, 0
    s_cbranch_scc1 LD_35
    s_sub_u32 s6, s6, 1
    s_branch LP_34
LD_35:
    v_add_f32_dpp v16, v16, v16 row_ror:8 row_mask:0xf bank_mask:0xf
    v_add_f32_dpp v17, v17, v17 row_ror:8 row_mask:0xf bank_mask:0xf
    v_add_f32_dpp v18, v18, v18 row_ror:8 row_mask:0xf bank_mask:0xf
    v_add_f32_dpp v19, v19, v19 row_ror:8 row_mask:0xf bank_mask:0xf
    v_mov_b32 v20, v16
    s_nop 1
    v_permlane16_swap_b32 v16, v20
    v_add_f32 v16, v16, v20
    v_mov_b32 v21, v17
    s_nop 1
    v_permlane16_swap_b32 v17, v21
    v_add_f32 v17, v17, v21
    v_mov_b32 v22, v18
    s_nop 1
    v_permlane16_swap_b32 v18, v22
    v_add_f32 v18, v18, v22
    v_mov_b32 v23, v19
    s_nop 1
    v_permlane16_swap_b32 v19, v23
    v_add_f32 v19, v19, v23
    v_mov_b32 v20, v16
    s_nop 1
    v_permlane32_swap_b32 v16, v20
    v_add_f32 v16, v16, v20
    v_mov_b32 v21, v17
    s_nop 1
    v_permlane32_swap_b32 v17, v21
    v_add_f32 v17, v17, v21
    v_mov_b32 v22, v18
    s_nop 1
    v_permlane32_swap_b32 v18, v22
    v_add_f32 v18, v18, v22
    v_mov_b32 v23, v19
    s_nop 1
    v_permlane32_swap_b32 v19, v23
    v_add_f32 v19, v19, v23
    s_lshl_b32 s58, s4, 7
    v_and_b32 v9, 7, v1
    v_lshlrev_b32 v9, 4, v9
    v_add_u32 v10, s58, v9
    ds_write_b128 v10, v[16:19] offset:58624
    s_waitcnt lgkmcnt(0)
    s_barrier
    ds_read_b128 v[16:19], v9 offset:58624
    ds_read_b128 v[20:23], v9 offset:58752
    ds_read_b128 v[24:27], v9 offset:58880
    ds_read_b128 v[28:31], v9 offset:59008
    s_waitcnt lgkmcnt(0)
    v_add_f32 v16, v16, v20
    v_add_f32 v24, v24, v28
    v_add_f32 v17, v17, v21
    v_add_f32 v25, v25, v29
    v_add_f32 v18, v18, v22
    v_add_f32 v26, v26, v30
    v_add_f32 v19, v19, v23
    v_add_f32 v27, v27, v31
    v_add_f32 v16, v16, v24
    v_add_f32 v17, v17, v25
    v_add_f32 v18, v18, v26
    v_add_f32 v19, v19, v27
    v_min_u32 v16, -2, v16
    v_min_u32 v17, -2, v17
    v_min_u32 v18, -2, v18
    v_min_u32 v19, -2, v19
    s_cmp_lg_u32 s4, 0
    s_cbranch_scc1 LS_36
    s_lshl_b32 s58, s3, 7
    s_add_u32 s58, s58, s5
    s_add_u32 s58, s58, 917504
    s_mov_b64 exec, 0xff
    buffer_store_dwordx4 v[16:19], v3, s[52:55], s58 offen sc1
    s_mov_b64 exec, -1
LS_36:
    s_cmp_lg_u32 s56, 0
    s_cselect_b32 s58, s97, 0
    s_cmp_lg_u32 s58, 0
    s_cbranch_scc1 L_END
    s_cmp_lg_u32 s4, 0
    s_cbranch_scc1 LS_37
    s_lshl_b32 s58, s57, 7
    s_add_u32 s58, s58, s5
    s_add_u32 s58, s58, 917504
    v_lshrrev_b32 v9, 3, v1
    v_lshlrev_b32 v9, 12, v9
    v_and_b32 v10, 7, v1
    v_lshlrev_b32 v10, 4, v10
    v_add_u32 v9, v9, v10
LP_38:
    buffer_load_dwordx4 v[16:19], v9, s[52:55], s58 offen sc1
    s_waitcnt vmcnt(0)
    v_max3_u32 v8, v16, v17, v18
    v_max_u32 v8, v8, v19
    v_cmp_eq_u32 vcc, -1, v8
    s_cbranch_vccz LD_39
    s_cmp_eq_u32 s6, 0
    s_cbranch_scc1 LD_39
    s_sub_u32 s6, s6, 1
    s_branch LP_38
LD_39:
    v_add_f32_dpp v16, v16, v16 row_ror:8 row_mask:0xf bank_mask:0xf
    v_add_f32_dpp v17, v17, v17 row_ror:8 row_mask:0xf bank_mask:0xf
    v_add_f32_dpp v18, v18, v18 row_ror:8 row_mask:0xf bank_mask:0xf
    v_add_f32_dpp v19, v19, v19 row_ror:8 row_mask:0xf bank_mask:0xf
    v_mov_b32 v20, v16
    s_nop 1
    v_permlane16_swap_b32 v16, v20
    v_add_f32 v16, v16, v20
    v_mov_b32 v21, v17
    s_nop 1
    v_permlane16_swap_b32 v17, v21
    v_add_f32 v17, v17, v21
    v_mov_b32 v22, v18
    s_nop 1
    v_permlane16_swap_b32 v18, v22
    v_add_f32 v18, v18, v22
    v_mov_b32 v23, v19
    s_nop 1
    v_permlane16_swap_b32 v19, v23
    v_add_f32 v19, v19, v23
    v_mov_b32 v20, v16
    s_nop 1
    v_permlane32_swap_b32 v16, v20
    v_add_f32 v16, v16, v20
    v_mov_b32 v21, v17
    s_nop 1
    v_permlane32_swap_b32 v17, v21
    v_add_f32 v17, v17, v21
    v_mov_b32 v22, v18
    s_nop 1
    v_permlane32_swap_b32 v18, v22
    v_add_f32 v18, v18, v22
    v_mov_b32 v23, v19
    s_nop 1
    v_permlane32_swap_b32 v19, v23
    v_add_f32 v19, v19, v23
    v_min_u32 v16, -2, v16
    v_min_u32 v17, -2, v17
    v_min_u32 v18, -2, v18
    v_min_u32 v19, -2, v19
    s_lshl_b32 s58, s3, 7
    s_add_u32 s58, s58, s5
    s_add_u32 s58, s58, 13172736
    s_mov_b64 exec, 0xff
    s_cmp_eq_u32 s7, 1
    s_cbranch_scc1 LF_40
    buffer_store_dwordx4 v[16:19], v3, s[52:55], s58 offen sc1
    s_branch LE_41
LF_40:
    buffer_store_dwordx4 v[16:19], v3, s[52:55], s58 offen
LE_41:
    s_mov_b64 exec, -1
LS_37:
    s_lshl_b32 s58, s56, 12
    s_lshl_b32 s59, s4, 10
    s_add_u32 s58, s58, s59
    s_add_u32 s58, s58, s5
    s_add_u32 s58, s58, 13172736
LP_42:
    buffer_load_dwordx4 v[16:19], v3, s[52:55], s58 offen sc1
    s_waitcnt vmcnt(0)
    v_max3_u32 v8, v16, v17, v18
    v_max_u32 v8, v8, v19
    v_cmp_eq_u32 vcc, -1, v8
    s_cbranch_vccz LD_43
    s_cmp_eq_u32 s6, 0
    s_cbranch_scc1 LD_43
    s_sub_u32 s6, s6, 1
    s_branch LP_42
LD_43:
    v_cvt_pk_bf16_f32 v16, v16, v16
    v_lshlrev_b32 v16, 16, v16
    v_cvt_pk_bf16_f32 v17, v17, v17
    v_lshlrev_b32 v17, 16, v17
    v_cvt_pk_bf16_f32 v18, v18, v18
    v_lshlrev_b32 v18, 16, v18
    v_cvt_pk_bf16_f32 v19, v19, v19
    v_lshlrev_b32 v19, 16, v19
    v_add_f32 v4, v4, v16
    v_add_f32 v5, v5, v17
    v_add_f32 v6, v6, v18
    v_add_f32 v7, v7, v19
    v_cvt_pk_bf16_f32 v4, v4, v4
    v_lshlrev_b32 v4, 16, v4
    v_cvt_pk_bf16_f32 v5, v5, v5
    v_lshlrev_b32 v5, 16, v5
    v_cvt_pk_bf16_f32 v6, v6, v6
    v_lshlrev_b32 v6, 16, v6
    v_cvt_pk_bf16_f32 v7, v7, v7
    v_lshlrev_b32 v7, 16, v7
    s_cmp_lg_u32 s97, 0
    s_cbranch_scc1 L_FINAL
    s_mov_b32 s5, 0x1000000
    s_mov_b32 s97, 1
    s_branch L_ALOOP
L_FINAL:
    s_cmp_lg_u32 s3, 0
    s_cbranch_scc1 L_END
    v_cvt_pk_bf16_f32 v16, v4, v5
    v_cvt_pk_bf16_f32 v17, v6, v7
    v_lshlrev_b32 v8, 3, v0
    buffer_store_dwordx2 v[16:17], v8, s[44:47], 0 offen
    s_branch L_END
L_GROUPB:
    s_cmp_ge_u32 s4, 2
    s_cbranch_scc1 LS_44
    s_and_b32 s58, s3, 3
    s_lshl_b32 s58, s58, 1
    s_add_u32 s58, s58, s4
    s_lshl_b32 s58, s58, 14
    s_lshr_b32 s59, s3, 2
    s_lshl_b32 s59, s59, 8
    s_add_u32 s58, s58, s59
    s_add_u32 s58, s58, s5
    buffer_store_dword v16, v2, s[52:55], s58 offen sc1
LS_44:
    s_and_b32 s58, s3, 7
    s_lshl_b32 s58, s58, 1
    s_lshr_b32 s59, s4, 1
    s_add_u32 s58, s58, s59
    s_lshl_b32 s58, s58, 11
    s_lshr_b32 s59, s3, 7
    s_lshl_b32 s59, s59, 10
    s_add_u32 s58, s58, s59
    s_and_b32 s59, s4, 1
    s_lshl_b32 s59, s59, 9
    s_add_u32 s58, s58, s59
    s_lshr_b32 s59, s3, 3
    s_and_b32 s59, s59, 15
    s_lshl_b32 s59, s59, 4
    s_add_u32 s58, s58, s59
    s_add_u32 s58, s58, s5
    s_add_u32 s58, s58, 131072
    v_and_b32 v8, 1, v1
    v_lshlrev_b32 v8, 15, v8
    v_lshrrev_b32 v9, 5, v1
    v_lshlrev_b32 v9, 8, v9
    v_add_u32 v8, v8, v9
    v_lshrrev_b32 v9, 4, v1
    v_and_b32 v9, 1, v9
    v_lshlrev_b32 v9, 3, v9
    v_add_u32 v8, v8, v9
    s_mov_b32 s60, 0x00030003
    s_mov_b32 s61, 0x00030003
    s_mov_b64 exec, s[60:61]
    buffer_store_dwordx2 v[16:17], v8, s[52:55], s58 offen sc1
    s_mov_b64 exec, -1
    s_cmp_lg_u32 s4, 0
    s_cbranch_scc1 LS_45
    s_lshl_b32 s58, s3, 10
    s_add_u32 s58, s58, s5
    s_add_u32 s58, s58, 12582912
    buffer_store_dwordx4 v[16:19], v3, s[52:55], s58 offen sc1
LS_45:
    s_and_b32 s58, s3, 7
    s_lshl_b32 s58, s58, 2
    s_add_u32 s58, s58, s4
    s_lshl_b32 s58, s58, 17
    s_lshr_b32 s59, s3, 3
    s_lshl_b32 s59, s59, 8
    s_add_u32 s58, s58, s59
    v_and_b32 v8, 15, v1
    v_lshlrev_b32 v8, 13, v8
    v_lshrrev_b32 v9, 4, v1
    v_lshlrev_b32 v9, 4, v9
    v_add_u32 v8, v8, v9
    buffer_load_dwordx4 a[56:59], v8, s[20:23], s58 offen
    buffer_load_dwordx4 a[60:63], v8, s[20:23], s58 offen offset:64
    buffer_load_dwordx4 a[64:67], v8, s[20:23], s58 offen offset:128
    buffer_load_dwordx4 a[68:71], v8, s[20:23], s58 offen offset:192
    s_waitcnt vmcnt(4)
    s_barrier
    s_cmp_lg_u32 s4, 0
    s_cbranch_scc1 LJ_46
    s_getreg_b32 s58, hwreg(HW_REG_XCC_ID)
    s_and_b32 s58, s58, 15
    s_mul_i32 s59, s58, s58
    s_lshl_b32 s59, s59, 16
    s_lshl_b32 s58, s58, 6
    s_add_u32 s58, s58, s59
    s_add_u32 s58, s58, 1
    v_mov_b32 v8, s58
    s_lshl_b32 s59, s56, 5
    v_mov_b32 v9, s59
    s_mov_b64 exec, 1
    buffer_atomic_add v8, v9, s[48:51], 0 offen sc1
    s_mov_b64 exec, -1
LJ_46:
    s_cmp_lg_u32 s4, 0
    s_cbranch_scc1 LS_47
    s_lshr_b32 s58, s3, 7
    s_lshl_b32 s58, s58, 15
    s_and_b32 s59, s3, 127
    s_lshl_b32 s59, s59, 5
    s_add_u32 s58, s58, s59
    s_add_u32 s58, s58, s5
    s_add_u32 s58, s58, 196608
    v_and_b32 v8, 31, v1
    v_lshrrev_b32 v9, 2, v8
    v_lshlrev_b32 v9, 12, v9
    v_and_b32 v8, 3, v8
    v_lshlrev_b32 v8, 2, v8
    v_add_u32 v8, v8, v9
    v_lshrrev_b32 v9, 5, v1
    v_lshlrev_b32 v9, 4, v9
    v_add_u32 v8, v8, v9
    buffer_store_dword v16, v8, s[52:55], s58 offen sc1
LS_47:
    v_mov_b32 v20, -1
    v_mov_b32 v21, -1
    v_mov_b32 v22, -1
    v_mov_b32 v23, -1
    s_and_b32 s58, s57, 3
    s_or_b32 s58, s58, s4
    s_cmp_lg_u32 s58, 0
    s_cbranch_scc1 LS_48
    s_lshr_b32 s58, s3, 2
    s_lshl_b32 s58, s58, 5
    s_add_u32 s58, s58, s5
    s_add_u32 s58, s58, 262144
    v_mov_b32 v8, 0
    s_mov_b64 exec, 1
    buffer_store_dwordx4 v[16:19], v8, s[52:55], s58 offen sc1
    buffer_store_dwordx4 v[20:23], v8, s[52:55], s58 offen offset:16 sc1
    s_mov_b64 exec, -1
LS_48:
    s_cmp_lg_u32 s4, 0
    s_cbranch_scc1 LS_49
    s_lshl_b32 s58, s3, 7
    s_add_u32 s58, s58, s5
    s_add_u32 s58, s58, 851968
    s_mov_b64 exec, 0xff
    buffer_store_dwordx4 v[16:19], v3, s[52:55], s58 offen sc1
    s_mov_b64 exec, -1
LS_49:
    s_cmp_lg_u32 s4, 0
    s_cbranch_scc1 LS_50
    s_lshl_b32 s58, s3, 7
    s_add_u32 s58, s58, s5
    s_add_u32 s58, s58, 917504
    s_mov_b64 exec, 0xff
    buffer_store_dwordx4 v[16:19], v3, s[52:55], s58 offen sc1
    s_mov_b64 exec, -1
LS_50:
    s_cmp_lg_u32 s4, 0
    s_cbranch_scc1 LS_51
    s_lshl_b32 s58, s3, 7
    s_add_u32 s58, s58, s5
    s_add_u32 s58, s58, 13107200
    s_mov_b64 exec, 0xff
    buffer_store_dwordx4 v[16:19], v3, s[52:55], s58 offen sc1
    s_mov_b64 exec, -1
    s_lshl_b32 s58, s3, 7
    s_add_u32 s58, s58, s5
    s_add_u32 s58, s58, 13172736
    s_mov_b64 exec, 0xff
    buffer_store_dwordx4 v[16:19], v3, s[52:55], s58 offen sc1
    s_mov_b64 exec, -1
LS_51:
    s_lshl_b32 s59, s4, 10
    s_lshl_b32 s58, s3, 12
    s_add_u32 s58, s58, s59
    s_add_u32 s58, s58, s5
    s_add_u32 s62, s58, 2097152
    buffer_store_dwordx4 v[16:19], v3, s[52:55], s62 offen sc1
    s_add_u32 s62, s58, 3145728
    buffer_store_dwordx4 v[16:19], v3, s[52:55], s62 offen sc1
    s_lshl_b32 s58, s57, 1
    s_lshr_b32 s62, s4, 1
    s_add_u32 s58, s58, s62
    s_lshl_b32 s58, s58, 14
    s_lshl_b32 s62, s56, 11
    s_add_u32 s58, s58, s62
    s_and_b32 s62, s4, 1
    s_lshl_b32 s62, s62, 10
    s_add_u32 s58, s58, s62
    s_add_u32 s58, s58, s5
    s_add_u32 s58, s58, 1048576
    buffer_store_dwordx4 v[16:19], v3, s[52:55], s58 offen sc1
    s_cmp_ge_u32 s4, 2
    s_cbranch_scc1 LS_52
    s_lshl_b32 s58, s3, 11
    s_add_u32 s58, s58, s59
    s_add_u32 s58, s58, s5
    s_add_u32 s58, s58, 327680
    buffer_store_dwordx4 v[16:19], v3, s[52:55], s58 offen sc1
LS_52:
L_BLOOP:
    s_barrier
    s_barrier
    s_barrier
    s_barrier
    s_cmp_lg_u32 s97, 0
    s_cbranch_scc1 LI_53
    v_and_b32 v10, 7, v1
    v_lshlrev_b32 v10, 5, v10
LP_54:
    buffer_load_dword v8, v10, s[48:51], 0 offen sc1
    s_waitcnt vmcnt(0)
    v_and_b32 v9, 63, v8
    v_cmp_ne_u32 vcc, 32, v9
    s_cbranch_vccz LD_55
    s_cmp_eq_u32 s6, 0
    s_cbranch_scc1 LD_55
    s_sub_u32 s6, s6, 1
    s_branch LP_54
LD_55:
    v_readlane_b32 s58, v8, s56
    s_nop 0
    s_lshr_b32 s59, s58, 16
    s_lshl_b32 s59, s59, 5
    s_lshr_b32 s58, s58, 6
    s_and_b32 s58, s58, 0x3ff
    s_mul_i32 s58, s58, s58
    s_cmp_eq_u32 s58, s59
    s_cselect_b32 s7, 1, 0
    v_mov_b32 v8, s7
    v_mov_b32 v9, 0
    ds_write_b32 v9, v8 offset:59136
LI_53:
    s_barrier
    s_lshr_b32 s58, s3, 3
    s_lshl_b32 s58, s58, 9
    s_add_u32 s58, s58, s5
    s_add_u32 s58, s58, 0
    s_add_u32 s59, s58, 32768
    s_add_u32 s62, s58, 65536
    s_add_u32 s63, s58, 98304
    v_lshrrev_b32 v9, 5, v1
    v_lshlrev_b32 v9, 14, v9
    v_and_b32 v10, 31, v1
    v_lshlrev_b32 v10, 4, v10
    v_add_u32 v9, v9, v10
LP_56:
    buffer_load_dwordx4 v[16:19], v9, s[52:55], s58 offen sc1
    buffer_load_dwordx4 v[20:23], v9, s[52:55], s59 offen sc1
    buffer_load_dwordx4 v[24:27], v9, s[52:55], s62 offen sc1
    buffer_load_dwordx4 v[28:31], v9, s[52:55], s63 offen sc1
    s_waitcnt vmcnt(0)
    v_max3_u32 v8, v16, v17, v18
    v_max3_u32 v8, v8, v19, v20
    v_max3_u32 v8, v8, v21, v22
    v_max3_u32 v8, v8, v23, v24
    v_max3_u32 v8, v8, v25, v26
    v_max3_u32 v8, v8, v27, v28
    v_max3_u32 v8, v8, v29, v30
    v_max_u32 v8, v8, v31
    v_cmp_eq_u32 vcc, -1, v8
    s_cbranch_vccz LD_57
    s_cmp_eq_u32 s6, 0
    s_cbranch_scc1 LD_57
    s_sub_u32 s6, s6, 1
    s_branch LP_56
LD_57:
    v_add_f32 v16, v16, v20
    v_add_f32 v24, v24, v28
    v_add_f32 v17, v17, v21
    v_add_f32 v25, v25, v29
    v_add_f32 v18, v18, v22
    v_add_f32 v26, v26, v30
    v_add_f32 v19, v19, v23
    v_add_f32 v27, v27, v31
    v_add_f32 v16, v16, v24
    v_add_f32 v17, v17, v25
    v_add_f32 v18, v18, v26
    v_add_f32 v19, v19, v27
    v_cvt_pk_bf16_f32 v20, v16, v17
    v_cvt_pk_bf16_f32 v21, v18, v19
    s_lshl_b32 s58, s4, 9
    v_lshlrev_b32 v8, 3, v1
    v_add_u32 v8, s58, v8
    ds_write_b64 v8, v[20:21] offset:55296
    v_and_b32 v8, 1, v1
    v_lshlrev_b32 v8, 8, v8
    v_lshrrev_b32 v9, 4, v1
    v_lshlrev_b32 v9, 4, v9
    v_add_u32 v8, v8, v9
    v_add_u32 v8, s58, v8
    s_waitcnt lgkmcnt(0)
    ds_read_b128 v[24:27], v8 offset:55296
    ds_read_b128 v[28:31], v8 offset:55360
    ds_read_b128 v[32:35], v8 offset:55424
    ds_read_b128 v[36:39], v8 offset:55488
    v_mov_b32 v16, 0
    v_mov_b32 v17, 0
    v_mov_b32 v18, 0
    v_mov_b32 v19, 0
    s_waitcnt lgkmcnt(0)
    s_nop 0
    v_mfma_f32_16x16x32_bf16 v[16:19], a[56:59], v[24:27], v[16:19]
    v_mfma_f32_16x16x32_bf16 v[16:19], a[60:63], v[28:31], v[16:19]
    v_mfma_f32_16x16x32_bf16 v[16:19], a[64:67], v[32:35], v[16:19]
    v_mfma_f32_16x16x32_bf16 v[16:19], a[68:71], v[36:39], v[16:19]
    s_mov_b32 s58, 0x3e0293ee
    s_nop 6
    v_mul_f32 v16, s58, v16
    v_mul_f32 v17, s58, v17
    v_mul_f32 v18, s58, v18
    v_mul_f32 v19, s58, v19
    v_cvt_pk_bf16_f32 v20, v16, v17
    v_cvt_pk_bf16_f32 v21, v18, v19
    v_min_u32 v20, -2, v20
    v_min_u32 v21, -2, v21
    s_and_b32 s58, s3, 7
    s_lshl_b32 s58, s58, 1
    s_lshr_b32 s59, s4, 1
    s_add_u32 s58, s58, s59
    s_lshl_b32 s58, s58, 11
    s_lshr_b32 s59, s3, 7
    s_lshl_b32 s59, s59, 10
    s_add_u32 s58, s58, s59
    s_and_b32 s59, s4, 1
    s_lshl_b32 s59, s59, 9
    s_add_u32 s58, s58, s59
    s_lshr_b32 s59, s3, 3
    s_and_b32 s59, s59, 15
    s_lshl_b32 s59, s59, 4
    s_add_u32 s58, s58, s59
    s_add_u32 s58, s58, s5
    s_add_u32 s58, s58, 131072
    v_and_b32 v8, 1, v1
    v_lshlrev_b32 v8, 15, v8
    v_lshrrev_b32 v9, 5, v1
    v_lshlrev_b32 v9, 8, v9
    v_add_u32 v8, v8, v9
    v_lshrrev_b32 v9, 4, v1
    v_and_b32 v9, 1, v9
    v_lshlrev_b32 v9, 3, v9
    v_add_u32 v8, v8, v9
    s_mov_b32 s60, 0x00030003
    s_mov_b32 s61, 0x00030003
    s_mov_b64 exec, s[60:61]
    buffer_store_dwordx2 v[20:21], v8, s[52:55], s58 offen sc1
    s_mov_b64 exec, -1
    s_cmp_lg_u32 s4, 0
    s_cbranch_scc1 LS_58
    s_lshr_b32 s58, s56, 2
    s_lshl_b32 s58, s58, 15
    s_lshl_b32 s59, s57, 10
    s_add_u32 s58, s58, s59
    s_add_u32 s58, s58, s5
    s_add_u32 s58, s58, 131072
LP_59:
    buffer_load_dwordx4 v[16:19], v3, s[52:55], s58 offen sc1
    s_waitcnt vmcnt(0)
    v_max3_u32 v8, v16, v17, v18
    v_max_u32 v8, v8, v19
    v_cmp_eq_u32 vcc, -1, v8
    s_cbranch_vccz LD_60
    s_cmp_eq_u32 s6, 0
    s_cbranch_scc1 LD_60
    s_sub_u32 s6, s6, 1
    s_branch LP_59
LD_60:
    s_lshl_b32 s58, s3, 10
    s_add_u32 s58, s58, s5
    s_add_u32 s58, s58, 12582912
    s_cmp_eq_u32 s7, 1
    s_cbranch_scc1 LF_61
    buffer_store_dwordx4 v[16:19], v3, s[52:55], s58 offen sc1
    s_branch LE_62
LF_61:
    buffer_store_dwordx4 v[16:19], v3, s[52:55], s58 offen
LE_62:
LS_58:
    s_barrier
    s_barrier
    s_cmp_lg_u32 s97, 0
    s_cbranch_scc1 LI_63
    s_lshl_b32 s58, s57, 17
    s_lshl_b32 s59, s56, 2
    s_add_u32 s59, s59, s4
    s_lshl_b32 s59, s59, 8
    s_add_u32 s58, s58, s59
    buffer_load_dword a0, v2, s[24:27], s58 offen nt
    s_add_u32 s58, s58, 8192
    buffer_load_dword a1, v2, s[24:27], s58 offen nt
    s_add_u32 s58, s58, 8192
    buffer_load_dword a2, v2, s[24:27], s58 offen nt
    s_add_u32 s58, s58, 8192
    buffer_load_dword a3, v2, s[24:27], s58 offen nt
    s_add_u32 s58, s58, 8192
    buffer_load_dword a4, v2, s[24:27], s58 offen nt
    s_add_u32 s58, s58, 8192
    buffer_load_dword a5, v2, s[24:27], s58 offen nt
    s_add_u32 s58, s58, 8192
    buffer_load_dword a6, v2, s[24:27], s58 offen nt
    s_add_u32 s58, s58, 8192
    buffer_load_dword a7, v2, s[24:27], s58 offen nt
    s_add_u32 s58, s58, 8192
LI_63:
    s_barrier
    s_cmp_lg_u32 s97, 0
    s_cbranch_scc1 LI_64
    s_lshl_b32 s58, s57, 17
    s_lshl_b32 s59, s56, 2
    s_add_u32 s59, s59, s4
    s_lshl_b32 s59, s59, 8
    s_add_u32 s58, s58, s59
    s_add_u32 s58, s58, 65536
    buffer_load_dword a8, v2, s[24:27], s58 offen nt
    s_add_u32 s58, s58, 8192
    buffer_load_dword a9, v2, s[24:27], s58 offen nt
    s_add_u32 s58, s58, 8192
    buffer_load_dword a10, v2, s[24:27], s58 offen nt
    s_add_u32 s58, s58, 8192
    buffer_load_dword a11, v2, s[24:27], s58 offen nt
    s_add_u32 s58, s58, 8192
    buffer_load_dword a12, v2, s[24:27], s58 offen nt
    s_add_u32 s58, s58, 8192
    buffer_load_dword a13, v2, s[24:27], s58 offen nt
    s_add_u32 s58, s58, 8192
    buffer_load_dword a14, v2, s[24:27], s58 offen nt
    s_add_u32 s58, s58, 8192
    buffer_load_dword a15, v2, s[24:27], s58 offen nt
    s_add_u32 s58, s58, 8192
LI_64:
    s_barrier
    s_cmp_lg_u32 s97, 0
    s_cbranch_scc1 LI_65
    s_lshl_b32 s58, s3, 14
    s_lshl_b32 s59, s4, 8
    s_add_u32 s58, s58, s59
    buffer_load_dword a16, v2, s[28:31], s58 offen nt
    buffer_load_dword a17, v2, s[28:31], s58 offen offset:1024 nt
    buffer_load_dword a18, v2, s[28:31], s58 offen offset:2048 nt
    buffer_load_dword a19, v2, s[28:31], s58 offen offset:3072 nt
    s_add_u32 s58, s58, 4096
    buffer_load_dword a20, v2, s[28:31], s58 offen nt
    buffer_load_dword a21, v2, s[28:31], s58 offen offset:1024 nt
    buffer_load_dword a22, v2, s[28:31], s58 offen offset:2048 nt
    buffer_load_dword a23, v2, s[28:31], s58 offen offset:3072 nt
    s_add_u32 s58, s58, 4096
LI_65:
    s_barrier
    s_cmp_lg_u32 s97, 0
    s_cbranch_scc1 LI_66
    s_lshl_b32 s58, s3, 14
    s_lshl_b32 s59, s4, 8
    s_add_u32 s58, s58, s59
    s_add_u32 s58, s58, 8192
    buffer_load_dword a24, v2, s[28:31], s58 offen nt
    buffer_load_dword a25, v2, s[28:31], s58 offen offset:1024 nt
    buffer_load_dword a26, v2, s[28:31], s58 offen offset:2048 nt
    buffer_load_dword a27, v2, s[28:31], s58 offen offset:3072 nt
    s_add_u32 s58, s58, 4096
    buffer_load_dword a28, v2, s[28:31], s58 offen nt
    buffer_load_dword a29, v2, s[28:31], s58 offen offset:1024 nt
    buffer_load_dword a30, v2, s[28:31], s58 offen offset:2048 nt
    buffer_load_dword a31, v2, s[28:31], s58 offen offset:3072 nt
    s_add_u32 s58, s58, 4096
LI_66:
    s_barrier
    s_barrier
    s_barrier
    s_lshl_b32 s58, s56, 13
    s_lshl_b32 s59, s57, 8
    s_add_u32 s58, s58, s59
    s_lshl_b32 s59, s4, 2
    s_add_u32 s58, s58, s59
    s_add_u32 s58, s58, s5
    s_add_u32 s58, s58, 327680
    s_add_u32 s59, s58, 262144
    v_lshrrev_b32 v9, 4, v1
    v_lshlrev_b32 v10, 16, v9
    v_and_b32 v11, 15, v1
    v_lshlrev_b32 v11, 4, v11
    v_add_u32 v10, v10, v11
    s_lshl_b32 s62, s56, 5
    s_lshl_b32 s63, s4, 2
    s_add_u32 s62, s62, s63
    s_add_u32 s62, s62, s5
    s_add_u32 s62, s62, 262144
    v_lshlrev_b32 v9, 8, v9
LP_67:
    buffer_load_dword v16, v10, s[52:55], s58 offen sc1
    buffer_load_dword v17, v10, s[52:55], s59 offen sc1
    buffer_load_dword v18, v9, s[52:55], s62 offen sc1
    buffer_load_dword v19, v9, s[52:55], s62 offen offset:1024 sc1
    buffer_load_dword v20, v9, s[52:55], s62 offen offset:16 sc1
    buffer_load_dword v21, v9, s[52:55], s62 offen offset:1040 sc1
    s_waitcnt vmcnt(0)
    v_max3_u32 v8, v16, v17, v18
    v_max3_u32 v8, v8, v19, v20
    v_max_u32 v8, v8, v21
    v_cmp_eq_u32 vcc, -1, v8
    s_cbranch_vccz LD_68
    s_cmp_eq_u32 s6, 0
    s_cbranch_scc1 LD_68
    s_sub_u32 s6, s6, 1
    s_branch LP_67
LD_68:
    v_mov_b32 v22, v18
    v_mov_b32 v23, v19
    v_mov_b32 v24, v22
    s_nop 1
    v_permlane16_swap_b32 v22, v24
    v_max_f32 v22, v22, v24
    v_mov_b32 v25, v23
    s_nop 1
    v_permlane16_swap_b32 v23, v25
    v_max_f32 v23, v23, v25
    v_mov_b32 v24, v22
    s_nop 1
    v_permlane32_swap_b32 v22, v24
    v_max_f32 v22, v22, v24
    v_mov_b32 v25, v23
    s_nop 1
    v_permlane32_swap_b32 v23, v25
    v_max_f32 v23, v23, v25
    v_sub_f32 v18, v18, v22
    v_sub_f32 v19, v19, v23
    v_exp_f32 v18, v18
    v_exp_f32 v19, v19
    v_mul_f32 v16, v16, v18
    v_mul_f32 v20, v20, v18
    v_mul_f32 v17, v17, v19
    v_mul_f32 v21, v21, v19
    v_mov_b32 v24, v16
    s_nop 1
    v_permlane16_swap_b32 v16, v24
    v_add_f32 v16, v16, v24
    v_mov_b32 v24, v17
    s_nop 1
    v_permlane16_swap_b32 v17, v24
    v_add_f32 v17, v17, v24
    v_mov_b32 v24, v20
    s_nop 1
    v_permlane16_swap_b32 v20, v24
    v_add_f32 v20, v20, v24
    v_mov_b32 v24, v21
    s_nop 1
    v_permlane16_swap_b32 v21, v24
    v_add_f32 v21, v21, v24
    v_mov_b32 v24, v16
    s_nop 1
    v_permlane32_swap_b32 v16, v24
    v_add_f32 v16, v16, v24
    v_mov_b32 v24, v17
    s_nop 1
    v_permlane32_swap_b32 v17, v24
    v_add_f32 v17, v17, v24
    v_mov_b32 v24, v20
    s_nop 1
    v_permlane32_swap_b32 v20, v24
    v_add_f32 v20, v20, v24
    v_mov_b32 v24, v21
    s_nop 1
    v_permlane32_swap_b32 v21, v24
    v_add_f32 v21, v21, v24
    v_rcp_f32 v22, v20
    v_rcp_f32 v23, v21
    v_mul_f32 v16, v16, v22
    v_mul_f32 v17, v17, v23
    v_readlane_b32 s64, v16, 0
    v_readlane_b32 s65, v16, 1
    v_readlane_b32 s66, v16, 2
    v_readlane_b32 s67, v16, 3
    v_readlane_b32 s68, v16, 4
    v_readlane_b32 s69, v16, 5
    v_readlane_b32 s70, v16, 6
    v_readlane_b32 s71, v16, 7
    v_readlane_b32 s72, v16, 8
    v_readlane_b32 s73, v16, 9
    v_readlane_b32 s74, v16, 10
    v_readlane_b32 s75, v16, 11
    v_readlane_b32 s76, v16, 12
    v_readlane_b32 s77, v16, 13
    v_readlane_b32 s78, v16, 14
    v_readlane_b32 s79, v16, 15
    v_readlane_b32 s80, v17, 0
    v_readlane_b32 s81, v17, 1
    v_readlane_b32 s82, v17, 2
    v_readlane_b32 s83, v17, 3
    v_readlane_b32 s84, v17, 4
    v_readlane_b32 s85, v17, 5
    v_readlane_b32 s86, v17, 6
    v_readlane_b32 s87, v17, 7
    v_readlane_b32 s88, v17, 8
    v_readlane_b32 s89, v17, 9
    v_readlane_b32 s90, v17, 10
    v_readlane_b32 s91, v17, 11
    v_readlane_b32 s92, v17, 12
    v_readlane_b32 s93, v17, 13
    v_readlane_b32 s94, v17, 14
    v_readlane_b32 s95, v17, 15
    v_mov_b32 v24, 0
    v_mov_b32 v25, 0
    v_mov_b32 v26, 0
    v_mov_b32 v27, 0
    v_accvgpr_read_b32 v28, a0
    v_lshlrev_b32 v29, 16, v28
    v_and_b32 v30, 0xffff0000, v28
    v_fma_f32 v24, s64, v29, v24
    v_fma_f32 v25, s64, v30, v25
    v_fma_f32 v26, s80, v29, v26
    v_fma_f32 v27, s80, v30, v27
    v_accvgpr_read_b32 v28, a1
    v_lshlrev_b32 v29, 16, v28
    v_and_b32 v30, 0xffff0000, v28
    v_fma_f32 v24, s65, v29, v24
    v_fma_f32 v25, s65, v30, v25
    v_fma_f32 v26, s81, v29, v26
    v_fma_f32 v27, s81, v30, v27
    v_accvgpr_read_b32 v28, a2
    v_lshlrev_b32 v29, 16, v28
    v_and_b32 v30, 0xffff0000, v28
    v_fma_f32 v24, s66, v29, v24
    v_fma_f32 v25, s66, v30, v25
    v_fma_f32 v26, s82, v29, v26
    v_fma_f32 v27, s82, v30, v27
    v_accvgpr_read_b32 v28, a3
    v_lshlrev_b32 v29, 16, v28
    v_and_b32 v30, 0xffff0000, v28
    v_fma_f32 v24, s67, v29, v24
    v_fma_f32 v25, s67, v30, v25
    v_fma_f32 v26, s83, v29, v26
    v_fma_f32 v27, s83, v30, v27
    v_accvgpr_read_b32 v28, a4
    v_lshlrev_b32 v29, 16, v28
    v_and_b32 v30, 0xffff0000, v28
    v_fma_f32 v24, s68, v29, v24
    v_fma_f32 v25, s68, v30, v25
    v_fma_f32 v26, s84, v29, v26
    v_fma_f32 v27, s84, v30, v27
    v_accvgpr_read_b32 v28, a5
    v_lshlrev_b32 v29, 16, v28
    v_and_b32 v30, 0xffff0000, v28
    v_fma_f32 v24, s69, v29, v24
    v_fma_f32 v25, s69, v30, v25
    v_fma_f32 v26, s85, v29, v26
    v_fma_f32 v27, s85, v30, v27
    v_accvgpr_read_b32 v28, a6
    v_lshlrev_b32 v29, 16, v28
    v_and_b32 v30, 0xffff0000, v28
    v_fma_f32 v24, s70, v29, v24
    v_fma_f32 v25, s70, v30, v25
    v_fma_f32 v26, s86, v29, v26
    v_fma_f32 v27, s86, v30, v27
    v_accvgpr_read_b32 v28, a7
    v_lshlrev_b32 v29, 16, v28
    v_and_b32 v30, 0xffff0000, v28
    v_fma_f32 v24, s71, v29, v24
    v_fma_f32 v25, s71, v30, v25
    v_fma_f32 v26, s87, v29, v26
    v_fma_f32 v27, s87, v30, v27
    v_accvgpr_read_b32 v28, a8
    v_lshlrev_b32 v29, 16, v28
    v_and_b32 v30, 0xffff0000, v28
    v_fma_f32 v24, s72, v29, v24
    v_fma_f32 v25, s72, v30, v25
    v_fma_f32 v26, s88, v29, v26
    v_fma_f32 v27, s88, v30, v27
    v_accvgpr_read_b32 v28, a9
    v_lshlrev_b32 v29, 16, v28
    v_and_b32 v30, 0xffff0000, v28
    v_fma_f32 v24, s73, v29, v24
    v_fma_f32 v25, s73, v30, v25
    v_fma_f32 v26, s89, v29, v26
    v_fma_f32 v27, s89, v30, v27
    v_accvgpr_read_b32 v28, a10
    v_lshlrev_b32 v29, 16, v28
    v_and_b32 v30, 0xffff0000, v28
    v_fma_f32 v24, s74, v29, v24
    v_fma_f32 v25, s74, v30, v25
    v_fma_f32 v26, s90, v29, v26
    v_fma_f32 v27, s90, v30, v27
    v_accvgpr_read_b32 v28, a11
    v_lshlrev_b32 v29, 16, v28
    v_and_b32 v30, 0xffff0000, v28
    v_fma_f32 v24, s75, v29, v24
    v_fma_f32 v25, s75, v30, v25
    v_fma_f32 v26, s91, v29, v26
    v_fma_f32 v27, s91, v30, v27
    v_accvgpr_read_b32 v28, a12
    v_lshlrev_b32 v29, 16, v28
    v_and_b32 v30, 0xffff0000, v28
    v_fma_f32 v24, s76, v29, v24
    v_fma_f32 v25, s76, v30, v25
    v_fma_f32 v26, s92, v29, v26
    v_fma_f32 v27, s92, v30, v27
    v_accvgpr_read_b32 v28, a13
    v_lshlrev_b32 v29, 16, v28
    v_and_b32 v30, 0xffff0000, v28
    v_fma_f32 v24, s77, v29, v24
    v_fma_f32 v25, s77, v30, v25
    v_fma_f32 v26, s93, v29, v26
    v_fma_f32 v27, s93, v30, v27
    v_accvgpr_read_b32 v28, a14
    v_lshlrev_b32 v29, 16, v28
    v_and_b32 v30, 0xffff0000, v28
    v_fma_f32 v24, s78, v29, v24
    v_fma_f32 v25, s78, v30, v25
    v_fma_f32 v26, s94, v29, v26
    v_fma_f32 v27, s94, v30, v27
    v_accvgpr_read_b32 v28, a15
    v_lshlrev_b32 v29, 16, v28
    v_and_b32 v30, 0xffff0000, v28
    v_fma_f32 v24, s79, v29, v24
    v_fma_f32 v25, s79, v30, v25
    v_fma_f32 v26, s95, v29, v26
    v_fma_f32 v27, s95, v30, v27
    v_min_u32 v24, -2, v24
    v_min_u32 v25, -2, v25
    v_min_u32 v26, -2, v26
    v_min_u32 v27, -2, v27
    s_lshl_b32 s58, s57, 15
    s_lshl_b32 s59, s56, 2
    s_add_u32 s59, s59, s4
    s_lshl_b32 s59, s59, 9
    s_add_u32 s58, s58, s59
    s_add_u32 s58, s58, s5
    s_add_u32 s58, s58, 1048576
    s_add_u32 s59, s58, 16384
    v_lshlrev_b32 v8, 3, v1
    s_cmp_eq_u32 s7, 1
    s_cbranch_scc1 LF_69
    buffer_store_dwordx2 v[24:25], v8, s[52:55], s58 offen sc1
    buffer_store_dwordx2 v[26:27], v8, s[52:55], s59 offen sc1
    s_branch LE_70
LF_69:
    buffer_store_dwordx2 v[24:25], v8, s[52:55], s58 offen
    buffer_store_dwordx2 v[26:27], v8, s[52:55], s59 offen
LE_70:
    s_lshl_b32 s58, s3, 6
    s_lshl_b32 s59, s4, 4
    s_add_u32 s58, s58, s59
    s_add_u32 s58, s58, s5
    s_add_u32 s58, s58, 1048576
    v_and_b32 v9, 31, v1
    v_lshlrev_b32 v9, 15, v9
    v_lshrrev_b32 v10, 5, v1
    v_lshlrev_b32 v10, 14, v10
    v_add_u32 v9, v9, v10
LP_71:
    buffer_load_dwordx4 v[16:19], v9, s[52:55], s58 offen sc1
    s_waitcnt vmcnt(0)
    v_max3_u32 v8, v16, v17, v18
    v_max_u32 v8, v8, v19
    v_cmp_eq_u32 vcc, -1, v8
    s_cbranch_vccz LD_72
    s_cmp_eq_u32 s6, 0
    s_cbranch_scc1 LD_72
    s_sub_u32 s6, s6, 1
    s_branch LP_71
LD_72:
    v_add_f32_dpp v16, v16, v16 row_shr:1 row_mask:0xf bank_mask:0xf
    v_add_f32_dpp v17, v17, v17 row_shr:1 row_mask:0xf bank_mask:0xf
    v_add_f32_dpp v18, v18, v18 row_shr:1 row_mask:0xf bank_mask:0xf
    v_add_f32_dpp v19, v19, v19 row_shr:1 row_mask:0xf bank_mask:0xf
    v_add_f32_dpp v16, v16, v16 row_shr:2 row_mask:0xf bank_mask:0xf
    v_add_f32_dpp v17, v17, v17 row_shr:2 row_mask:0xf bank_mask:0xf
    v_add_f32_dpp v18, v18, v18 row_shr:2 row_mask:0xf bank_mask:0xf
    v_add_f32_dpp v19, v19, v19 row_shr:2 row_mask:0xf bank_mask:0xf
    v_add_f32_dpp v16, v16, v16 row_shr:4 row_mask:0xf bank_mask:0xf
    v_add_f32_dpp v17, v17, v17 row_shr:4 row_mask:0xf bank_mask:0xf
    v_add_f32_dpp v18, v18, v18 row_shr:4 row_mask:0xf bank_mask:0xf
    v_add_f32_dpp v19, v19, v19 row_shr:4 row_mask:0xf bank_mask:0xf
    v_add_f32_dpp v16, v16, v16 row_shr:8 row_mask:0xf bank_mask:0xf
    v_add_f32_dpp v17, v17, v17 row_shr:8 row_mask:0xf bank_mask:0xf
    v_add_f32_dpp v18, v18, v18 row_shr:8 row_mask:0xf bank_mask:0xf
    v_add_f32_dpp v19, v19, v19 row_shr:8 row_mask:0xf bank_mask:0xf
    v_add_f32_dpp v16, v16, v16 row_bcast:15 row_mask:0xa bank_mask:0xf
    v_add_f32_dpp v17, v17, v17 row_bcast:15 row_mask:0xa bank_mask:0xf
    v_add_f32_dpp v18, v18, v18 row_bcast:15 row_mask:0xa bank_mask:0xf
    v_add_f32_dpp v19, v19, v19 row_bcast:15 row_mask:0xa bank_mask:0xf
    v_cvt_pk_bf16_f32 v16, v16, v16
    v_lshlrev_b32 v16, 16, v16
    v_cvt_pk_bf16_f32 v17, v17, v17
    v_lshlrev_b32 v17, 16, v17
    v_cvt_pk_bf16_f32 v18, v18, v18
    v_lshlrev_b32 v18, 16, v18
    v_cvt_pk_bf16_f32 v19, v19, v19
    v_lshlrev_b32 v19, 16, v19
    v_lshrrev_b32 v9, 5, v1
    v_lshlrev_b32 v9, 6, v9
    s_lshl_b32 s58, s4, 4
    v_add_u32 v9, s58, v9
    s_mov_b32 s60, 0x80000000
    s_mov_b32 s61, 0x80000000
    s_mov_b64 exec, s[60:61]
    ds_write_b128 v9, v[16:19] offset:57344
    s_mov_b64 exec, -1
    s_waitcnt lgkmcnt(0)
    s_barrier
    v_mov_b32 v9, 0
    ds_read_b128 v[32:35], v9 offset:57344
    ds_read_b128 v[36:39], v9 offset:57360
    ds_read_b128 v[40:43], v9 offset:57376
    ds_read_b128 v[44:47], v9 offset:57392
    ds_read_b128 v[48:51], v9 offset:57408
    ds_read_b128 v[52:55], v9 offset:57424
    ds_read_b128 v[56:59], v9 offset:57440
    ds_read_b128 v[60:63], v9 offset:57456
    v_mov_b32 v24, 0
    v_mov_b32 v25, 0
    v_mov_b32 v26, 0
    v_mov_b32 v27, 0
    s_waitcnt lgkmcnt(0)
    v_accvgpr_read_b32 v28, a16
    v_lshlrev_b32 v29, 16, v28
    v_and_b32 v30, 0xffff0000, v28
    v_fmac_f32 v24, v32, v29
    v_fmac_f32 v25, v32, v30
    v_fmac_f32 v26, v48, v29
    v_fmac_f32 v27, v48, v30
    v_accvgpr_read_b32 v28, a17
    v_lshlrev_b32 v29, 16, v28
    v_and_b32 v30, 0xffff0000, v28
    v_fmac_f32 v24, v33, v29
    v_fmac_f32 v25, v33, v30
    v_fmac_f32 v26, v49, v29
    v_fmac_f32 v27, v49, v30
    v_accvgpr_read_b32 v28, a18
    v_lshlrev_b32 v29, 16, v28
    v_and_b32 v30, 0xffff0000, v28
    v_fmac_f32 v24, v34, v29
    v_fmac_f32 v25, v34, v30
    v_fmac_f32 v26, v50, v29
    v_fmac_f32 v27, v50, v30
    v_accvgpr_read_b32 v28, a19
    v_lshlrev_b32 v29, 16, v28
    v_and_b32 v30, 0xffff0000, v28
    v_fmac_f32 v24, v35, v29
    v_fmac_f32 v25, v35, v30
    v_fmac_f32 v26, v51, v29
    v_fmac_f32 v27, v51, v30
    v_accvgpr_read_b32 v28, a20
    v_lshlrev_b32 v29, 16, v28
    v_and_b32 v30, 0xffff0000, v28
    v_fmac_f32 v24, v36, v29
    v_fmac_f32 v25, v36, v30
    v_fmac_f32 v26, v52, v29
    v_fmac_f32 v27, v52, v30
    v_accvgpr_read_b32 v28, a21
    v_lshlrev_b32 v29, 16, v28
    v_and_b32 v30, 0xffff0000, v28
    v_fmac_f32 v24, v37, v29
    v_fmac_f32 v25, v37, v30
    v_fmac_f32 v26, v53, v29
    v_fmac_f32 v27, v53, v30
    v_accvgpr_read_b32 v28, a22
    v_lshlrev_b32 v29, 16, v28
    v_and_b32 v30, 0xffff0000, v28
    v_fmac_f32 v24, v38, v29
    v_fmac_f32 v25, v38, v30
    v_fmac_f32 v26, v54, v29
    v_fmac_f32 v27, v54, v30
    v_accvgpr_read_b32 v28, a23
    v_lshlrev_b32 v29, 16, v28
    v_and_b32 v30, 0xffff0000, v28
    v_fmac_f32 v24, v39, v29
    v_fmac_f32 v25, v39, v30
    v_fmac_f32 v26, v55, v29
    v_fmac_f32 v27, v55, v30
    v_accvgpr_read_b32 v28, a24
    v_lshlrev_b32 v29, 16, v28
    v_and_b32 v30, 0xffff0000, v28
    v_fmac_f32 v24, v40, v29
    v_fmac_f32 v25, v40, v30
    v_fmac_f32 v26, v56, v29
    v_fmac_f32 v27, v56, v30
    v_accvgpr_read_b32 v28, a25
    v_lshlrev_b32 v29, 16, v28
    v_and_b32 v30, 0xffff0000, v28
    v_fmac_f32 v24, v41, v29
    v_fmac_f32 v25, v41, v30
    v_fmac_f32 v26, v57, v29
    v_fmac_f32 v27, v57, v30
    v_accvgpr_read_b32 v28, a26
    v_lshlrev_b32 v29, 16, v28
    v_and_b32 v30, 0xffff0000, v28
    v_fmac_f32 v24, v42, v29
    v_fmac_f32 v25, v42, v30
    v_fmac_f32 v26, v58, v29
    v_fmac_f32 v27, v58, v30
    v_accvgpr_read_b32 v28, a27
    v_lshlrev_b32 v29, 16, v28
    v_and_b32 v30, 0xffff0000, v28
    v_fmac_f32 v24, v43, v29
    v_fmac_f32 v25, v43, v30
    v_fmac_f32 v26, v59, v29
    v_fmac_f32 v27, v59, v30
    v_accvgpr_read_b32 v28, a28
    v_lshlrev_b32 v29, 16, v28
    v_and_b32 v30, 0xffff0000, v28
    v_fmac_f32 v24, v44, v29
    v_fmac_f32 v25, v44, v30
    v_fmac_f32 v26, v60, v29
    v_fmac_f32 v27, v60, v30
    v_accvgpr_read_b32 v28, a29
    v_lshlrev_b32 v29, 16, v28
    v_and_b32 v30, 0xffff0000, v28
    v_fmac_f32 v24, v45, v29
    v_fmac_f32 v25, v45, v30
    v_fmac_f32 v26, v61, v29
    v_fmac_f32 v27, v61, v30
    v_accvgpr_read_b32 v28, a30
    v_lshlrev_b32 v29, 16, v28
    v_and_b32 v30, 0xffff0000, v28
    v_fmac_f32 v24, v46, v29
    v_fmac_f32 v25, v46, v30
    v_fmac_f32 v26, v62, v29
    v_fmac_f32 v27, v62, v30
    v_accvgpr_read_b32 v28, a31
    v_lshlrev_b32 v29, 16, v28
    v_and_b32 v30, 0xffff0000, v28
    v_fmac_f32 v24, v47, v29
    v_fmac_f32 v25, v47, v30
    v_fmac_f32 v26, v63, v29
    v_fmac_f32 v27, v63, v30
    v_min_u32 v24, -2, v24
    v_min_u32 v25, -2, v25
    v_min_u32 v26, -2, v26
    v_min_u32 v27, -2, v27
    s_lshl_b32 s58, s3, 12
    s_lshl_b32 s59, s4, 9
    s_add_u32 s58, s58, s59
    s_add_u32 s58, s58, s5
    s_add_u32 s58, s58, 2097152
    v_lshlrev_b32 v8, 3, v1
    s_cmp_eq_u32 s7, 1
    s_cbranch_scc1 LF_73
    buffer_store_dwordx2 v[24:25], v8, s[52:55], s58 offen sc1
    buffer_store_dwordx2 v[26:27], v8, s[52:55], s58 offen offset:2048 sc1
    s_branch LE_74
LF_73:
    buffer_store_dwordx2 v[24:25], v8, s[52:55], s58 offen
    buffer_store_dwordx2 v[26:27], v8, s[52:55], s58 offen offset:2048
LE_74:
    s_lshl_b32 s58, s56, 5
    s_lshl_b32 s59, s4, 3
    s_add_u32 s58, s58, s59
    s_lshl_b32 s58, s58, 12
    s_lshl_b32 s59, s57, 7
    s_add_u32 s58, s58, s59
    s_add_u32 s58, s58, s5
    s_add_u32 s58, s58, 2097152
    v_lshrrev_b32 v9, 3, v1
    v_lshlrev_b32 v9, 12, v9
    v_and_b32 v10, 7, v1
    v_lshlrev_b32 v10, 4, v10
    v_add_u32 v9, v9, v10
LP_75:
    buffer_load_dwordx4 v[16:19], v9, s[52:55], s58 offen sc1
    s_waitcnt vmcnt(0)
    v_max3_u32 v8, v16, v17, v18
    v_max_u32 v8, v8, v19
    v_cmp_eq_u32 vcc, -1, v8
    s_cbranch_vccz LD_76
    s_cmp_eq_u32 s6, 0
    s_cbranch_scc1 LD_76
    s_sub_u32 s6, s6, 1
    s_branch LP_75
LD_76:
    v_add_f32_dpp v16, v16, v16 row_ror:8 row_mask:0xf bank_mask:0xf
    v_add_f32_dpp v17, v17, v17 row_ror:8 row_mask:0xf bank_mask:0xf
    v_add_f32_dpp v18, v18, v18 row_ror:8 row_mask:0xf bank_mask:0xf
    v_add_f32_dpp v19, v19, v19 row_ror:8 row_mask:0xf bank_mask:0xf
    v_mov_b32 v20, v16
    s_nop 1
    v_permlane16_swap_b32 v16, v20
    v_add_f32 v16, v16, v20
    v_mov_b32 v21, v17
    s_nop 1
    v_permlane16_swap_b32 v17, v21
    v_add_f32 v17, v17, v21
    v_mov_b32 v22, v18
    s_nop 1
    v_permlane16_swap_b32 v18, v22
    v_add_f32 v18, v18, v22
    v_mov_b32 v23, v19
    s_nop 1
    v_permlane16_swap_b32 v19, v23
    v_add_f32 v19, v19, v23
    v_mov_b32 v20, v16
    s_nop 1
    v_permlane32_swap_b32 v16, v20
    v_add_f32 v16, v16, v20
    v_mov_b32 v21, v17
    s_nop 1
    v_permlane32_swap_b32 v17, v21
    v_add_f32 v17, v17, v21
    v_mov_b32 v22, v18
    s_nop 1
    v_permlane32_swap_b32 v18, v22
    v_add_f32 v18, v18, v22
    v_mov_b32 v23, v19
    s_nop 1
    v_permlane32_swap_b32 v19, v23
    v_add_f32 v19, v19, v23
    s_lshl_b32 s58, s4, 7
    v_and_b32 v9, 7, v1
    v_lshlrev_b32 v9, 4, v9
    v_add_u32 v10, s58, v9
    ds_write_b128 v10, v[16:19] offset:57600
    s_waitcnt lgkmcnt(0)
    s_barrier
    ds_read_b128 v[16:19], v9 offset:57600
    ds_read_b128 v[20:23], v9 offset:57728
    ds_read_b128 v[24:27], v9 offset:57856
    ds_read_b128 v[28:31], v9 offset:57984
    s_waitcnt lgkmcnt(0)
    v_add_f32 v16, v16, v20
    v_add_f32 v24, v24, v28
    v_add_f32 v17, v17, v21
    v_add_f32 v25, v25, v29
    v_add_f32 v18, v18, v22
    v_add_f32 v26, v26, v30
    v_add_f32 v19, v19, v23
    v_add_f32 v27, v27, v31
    v_add_f32 v16, v16, v24
    v_add_f32 v17, v17, v25
    v_add_f32 v18, v18, v26
    v_add_f32 v19, v19, v27
    v_min_u32 v16, -2, v16
    v_min_u32 v17, -2, v17
    v_min_u32 v18, -2, v18
    v_min_u32 v19, -2, v19
    s_cmp_lg_u32 s4, 0
    s_cbranch_scc1 LS_77
    s_lshl_b32 s58, s3, 7
    s_add_u32 s58, s58, s5
    s_add_u32 s58, s58, 851968
    s_mov_b64 exec, 0xff
    buffer_store_dwordx4 v[16:19], v3, s[52:55], s58 offen sc1
    s_mov_b64 exec, -1
LS_77:
    s_barrier
    s_cmp_lg_u32 s97, 0
    s_cbranch_scc1 L_END
    v_mov_b32 v16, -1
    v_mov_b32 v17, -1
    v_mov_b32 v18, -1
    v_mov_b32 v19, -1
    s_mov_b32 s5, 0x1000000
    s_cmp_ge_u32 s4, 2
    s_cbranch_scc1 LS_78
    s_and_b32 s58, s3, 3
    s_lshl_b32 s58, s58, 1
    s_add_u32 s58, s58, s4
    s_lshl_b32 s58, s58, 14
    s_lshr_b32 s59, s3, 2
    s_lshl_b32 s59, s59, 8
    s_add_u32 s58, s58, s59
    s_add_u32 s58, s58, s5
    buffer_store_dword v16, v2, s[52:55], s58 offen sc1
LS_78:
    s_and_b32 s58, s3, 7
    s_lshl_b32 s58, s58, 1
    s_lshr_b32 s59, s4, 1
    s_add_u32 s58, s58, s59
    s_lshl_b32 s58, s58, 11
    s_lshr_b32 s59, s3, 7
    s_lshl_b32 s59, s59, 10
    s_add_u32 s58, s58, s59
    s_and_b32 s59, s4, 1
    s_lshl_b32 s59, s59, 9
    s_add_u32 s58, s58, s59
    s_lshr_b32 s59, s3, 3
    s_and_b32 s59, s59, 15
    s_lshl_b32 s59, s59, 4
    s_add_u32 s58, s58, s59
    s_add_u32 s58, s58, s5
    s_add_u32 s58, s58, 131072
    v_and_b32 v8, 1, v1
    v_lshlrev_b32 v8, 15, v8
    v_lshrrev_b32 v9, 5, v1
    v_lshlrev_b32 v9, 8, v9
    v_add_u32 v8, v8, v9
    v_lshrrev_b32 v9, 4, v1
    v_and_b32 v9, 1, v9
    v_lshlrev_b32 v9, 3, v9
    v_add_u32 v8, v8, v9
    s_mov_b32 s60, 0x00030003
    s_mov_b32 s61, 0x00030003
    s_mov_b64 exec, s[60:61]
    buffer_store_dwordx2 v[16:17], v8, s[52:55], s58 offen sc1
    s_mov_b64 exec, -1
    s_cmp_lg_u32 s4, 0
    s_cbranch_scc1 LS_79
    s_lshl_b32 s58, s3, 10
    s_add_u32 s58, s58, s5
    s_add_u32 s58, s58, 12582912
    buffer_store_dwordx4 v[16:19], v3, s[52:55], s58 offen sc1
LS_79:
    s_cmp_lg_u32 s4, 0
    s_cbranch_scc1 LS_80
    s_lshr_b32 s58, s3, 7
    s_lshl_b32 s58, s58, 15
    s_and_b32 s59, s3, 127
    s_lshl_b32 s59, s59, 5
    s_add_u32 s58, s58, s59
    s_add_u32 s58, s58, s5
    s_add_u32 s58, s58, 196608
    v_and_b32 v8, 31, v1
    v_lshrrev_b32 v9, 2, v8
    v_lshlrev_b32 v9, 12, v9
    v_and_b32 v8, 3, v8
    v_lshlrev_b32 v8, 2, v8
    v_add_u32 v8, v8, v9
    v_lshrrev_b32 v9, 5, v1
    v_lshlrev_b32 v9, 4, v9
    v_add_u32 v8, v8, v9
    buffer_store_dword v16, v8, s[52:55], s58 offen sc1
LS_80:
    v_mov_b32 v20, -1
    v_mov_b32 v21, -1
    v_mov_b32 v22, -1
    v_mov_b32 v23, -1
    s_and_b32 s58, s57, 3
    s_or_b32 s58, s58, s4
    s_cmp_lg_u32 s58, 0
    s_cbranch_scc1 LS_81
    s_lshr_b32 s58, s3, 2
    s_lshl_b32 s58, s58, 5
    s_add_u32 s58, s58, s5
    s_add_u32 s58, s58, 262144
    v_mov_b32 v8, 0
    s_mov_b64 exec, 1
    buffer_store_dwordx4 v[16:19], v8, s[52:55], s58 offen sc1
    buffer_store_dwordx4 v[20:23], v8, s[52:55], s58 offen offset:16 sc1
    s_mov_b64 exec, -1
LS_81:
    s_cmp_lg_u32 s4, 0
    s_cbranch_scc1 LS_82
    s_lshl_b32 s58, s3, 7
    s_add_u32 s58, s58, s5
    s_add_u32 s58, s58, 851968
    s_mov_b64 exec, 0xff
    buffer_store_dwordx4 v[16:19], v3, s[52:55], s58 offen sc1
    s_mov_b64 exec, -1
LS_82:
    s_cmp_lg_u32 s4, 0
    s_cbranch_scc1 LS_83
    s_lshl_b32 s58, s3, 7
    s_add_u32 s58, s58, s5
    s_add_u32 s58, s58, 917504
    s_mov_b64 exec, 0xff
    buffer_store_dwordx4 v[16:19], v3, s[52:55], s58 offen sc1
    s_mov_b64 exec, -1
LS_83:
    s_cmp_lg_u32 s4, 0
    s_cbranch_scc1 LS_84
    s_lshl_b32 s58, s3, 7
    s_add_u32 s58, s58, s5
    s_add_u32 s58, s58, 13107200
    s_mov_b64 exec, 0xff
    buffer_store_dwordx4 v[16:19], v3, s[52:55], s58 offen sc1
    s_mov_b64 exec, -1
    s_lshl_b32 s58, s3, 7
    s_add_u32 s58, s58, s5
    s_add_u32 s58, s58, 13172736
    s_mov_b64 exec, 0xff
    buffer_store_dwordx4 v[16:19], v3, s[52:55], s58 offen sc1
    s_mov_b64 exec, -1
LS_84:
    s_lshl_b32 s59, s4, 10
    s_lshl_b32 s58, s3, 12
    s_add_u32 s58, s58, s59
    s_add_u32 s58, s58, s5
    s_add_u32 s62, s58, 2097152
    buffer_store_dwordx4 v[16:19], v3, s[52:55], s62 offen sc1
    s_add_u32 s62, s58, 3145728
    buffer_store_dwordx4 v[16:19], v3, s[52:55], s62 offen sc1
    s_lshl_b32 s58, s57, 1
    s_lshr_b32 s62, s4, 1
    s_add_u32 s58, s58, s62
    s_lshl_b32 s58, s58, 14
    s_lshl_b32 s62, s56, 11
    s_add_u32 s58, s58, s62
    s_and_b32 s62, s4, 1
    s_lshl_b32 s62, s62, 10
    s_add_u32 s58, s58, s62
    s_add_u32 s58, s58, s5
    s_add_u32 s58, s58, 1048576
    buffer_store_dwordx4 v[16:19], v3, s[52:55], s58 offen sc1
    s_cmp_ge_u32 s4, 2
    s_cbranch_scc1 LS_85
    s_lshl_b32 s58, s3, 11
    s_add_u32 s58, s58, s59
    s_add_u32 s58, s58, s5
    s_add_u32 s58, s58, 327680
    buffer_store_dwordx4 v[16:19], v3, s[52:55], s58 offen sc1
LS_85:
    s_waitcnt vmcnt(0)
    s_barrier
    s_barrier
    s_barrier
    s_barrier
    s_barrier
    s_mov_b32 s97, 1
    s_branch L_BLOOP
L_END:
    s_endpgm
.section .rodata,"a"
.p2align 6
.amdhsa_kernel interleave_layers__compressed_kv_cla__glu_gated_swiglu__decode_kernel
  .amdhsa_next_free_vgpr 256
  .amdhsa_next_free_sgpr 102
  .amdhsa_accum_offset 176
  .amdhsa_group_segment_fixed_size 0
  .amdhsa_kernarg_size 104
  .amdhsa_user_sgpr_count 2
  .amdhsa_user_sgpr_kernarg_segment_ptr 1
  .amdhsa_system_sgpr_workgroup_id_x 1
.end_amdhsa_kernel
```
